```python
import torch

def _softmax(x, axis=-1):
    return torch.softmax(x, dim=axis)
def _gelu(x):
    return torch.nn.functional.gelu(x, approximate="tanh")
def _silu(x):
    return torch.nn.functional.silu(x)
def _sigmoid(x):
    return torch.sigmoid(x)
def _layernorm(x, axis=-1, eps=1e-5):
    m = x.mean(dim=axis, keepdim=True)
    v = x.var(dim=axis, keepdim=True, unbiased=False)
    return (x - m) / torch.sqrt(v + eps)
def _scatter_add(tgt, idx, src, axis=0):
    return tgt.clone().index_add_(axis, idx, src)
def _segment_sum(src, seg, n):
    out = torch.zeros((n,) + src.shape[1:], dtype=src.dtype)
    return out.index_add_(0, seg, src)
def _pad(x, pw):
    flat = tuple(v for pair in reversed(pw) for v in pair)
    return torch.nn.functional.pad(x, flat)

kernel_name = 'standalone__gqa_softmax__near_ridge'

def setup_inputs():

    _w = (lambda a: (lambda t: t.to(torch.bfloat16) if t.is_floating_point() else t)(torch.as_tensor(a)))
    B, Hq, Hkv, Sq, Sk, D = 8, 16, 8, 144, 1024, 256
    return {
        "q": _w((lambda *s: torch.randn(*s, dtype=torch.bfloat16) * 0.8)(B, Hq, Sq, D)),
        "k": _w((lambda *s: torch.randn(*s, dtype=torch.bfloat16) * 0.8)(B, Hkv, Sk, D)),
        "v": _w((lambda *s: torch.randn(*s, dtype=torch.bfloat16) * 0.05)(B, Hkv, Sk, D)),
    }

def reference(q, k, v):
    B, Hq, Sq, D = q.shape
    Hkv = k.shape[1]
    rep = Hq // Hkv
    k = (lambda x, n, axis: torch.repeat_interleave(x, n, dim=axis))(k, rep, axis=1)
    v = (lambda x, n, axis: torch.repeat_interleave(x, n, dim=axis))(v, rep, axis=1)
    scale = D ** -0.5
    scores = torch.einsum("bhqd,bhkd->bhqk", q, k) * scale
    p = _softmax(scores, axis=-1)
    return torch.einsum("bhqk,bhkd->bhqd", p, v)
```

```asm
; @launch grid=(256,1,1) block=(512,1,1) lds=163840
.amdgcn_target "amdgcn-amd-amdhsa--gfx950"
.text
.globl standalone__gqa_softmax__near_ridge_kernel
.p2align 8
.type standalone__gqa_softmax__near_ridge_kernel,@function
standalone__gqa_softmax__near_ridge_kernel:
    s_load_dwordx4 s[4:7], s[0:1], 0
    s_cmp_ge_u32 s2, 256
    s_cbranch_scc1 L_done
    v_and_b32 v100, 63, v0
    v_lshrrev_b32 v101, 6, v0
    s_and_b32 s3, s2, 7
    s_lshr_b32 s36, s2, 3
    v_readfirstlane_b32 s41, v101
    s_and_b32 s28, s36, 3
    s_lshr_b32 s36, s36, 2
    s_lshl_b32 s36, s36, 3
    s_add_u32 s29, s36, s3
    v_lshrrev_b32 v107, 4, v100
    v_lshrrev_b32 v103, 3, v100
    v_lshlrev_b32 v103, 9, v103
    v_lshlrev_b32 v104, 1, v107
    v_and_b32 v105, 7, v100
    v_xor_b32 v104, v104, v105
    v_lshl_add_u32 v103, v104, 4, v103
    v_add_u32 v106, 3072, v103
    s_mul_i32 s36, s29, 147456
    s_mul_i32 s37, s28, 40960
    s_lshl_b32 s40, s28, 15
    s_add_u32 s40, s40, 16384
    s_min_u32 s37, s37, s40
    s_cmp_lt_u32 s28, 2
    s_mov_b32 s14, 32768
    s_cselect_b32 s14, 40960, s14
    s_add_u32 s36, s36, s37
    s_and_b32 s30, s41, 3
    s_lshr_b32 s37, s41, 2
    s_lshl_b32 s40, s30, 7
    s_lshl_b32 s42, s37, 13
    s_add_u32 s40, s40, s42
    s_lshl_b32 s42, s30, 11
    s_lshl_b32 s43, s37, 15
    s_add_u32 s43, s43, s42
    s_mov_b32 s15, 0x20000
    s_add_u32 m0, s43, 24576
    s_waitcnt lgkmcnt(0)
    s_add_u32 s12, s4, s36
    s_addc_u32 s13, s5, 0
    buffer_load_dwordx4 v103, s[12:15], s40 offen nt lds
    buffer_load_dwordx4 v106, s[12:15], s40 offen offset:1024 nt lds
    s_add_u32 s40, s40, 16384
    s_add_u32 m0, s43, 90112
    s_load_dwordx4 s[8:11], s[0:1], 16
    buffer_load_dwordx4 v103, s[12:15], s40 offen nt lds
    buffer_load_dwordx4 v106, s[12:15], s40 offen offset:1024 nt lds
    s_cmp_ge_u32 s41, 4
    s_cbranch_scc1 L_noq4
    s_add_u32 s40, s40, 16384
    s_add_u32 m0, s42, 131072
    s_nop 0
    buffer_load_dwordx4 v103, s[12:15], s40 offen nt lds
    buffer_load_dwordx4 v106, s[12:15], s40 offen offset:1024 nt lds
L_noq4:
    v_and_b32 v102, 3, v101
    v_lshl_add_u32 v114, v102, 13, v103
    v_add_u32 v115, 3072, v114
    s_lshl_b32 s37, s29, 19
    s_mul_i32 s31, s30, 32768
    s_add_u32 s16, s6, s37
    s_addc_u32 s17, s7, 0
    s_mov_b32 s18, 524288
    s_mov_b32 s19, 0x20000
    s_cmp_ge_u32 s41, 4
    s_cbranch_scc1 L_nok0
    s_add_u32 m0, s31, 0
    s_nop 0
    buffer_load_dwordx4 v114, s[16:19], 0 offen offset:0  lds
    buffer_load_dwordx4 v115, s[16:19], 0 offen offset:1024  lds
L_nok0:
    s_cmp_eq_u32 s28, 0
    s_cbranch_scc0 L_tab1
    s_mov_b32 s64, 0
    s_mov_b32 s65, 65536
    s_mov_b32 s66, 32768
    s_mov_b32 s67, 98304
    s_mov_b32 s68, 131072
    s_mov_b32 s69, 262144
    s_mov_b32 s70, 163840
    s_mov_b32 s71, 196608
    s_mov_b32 s72, 229376
    s_mov_b32 s73, 294912
    s_mov_b32 s74, 327680
    s_mov_b32 s75, 458752
    s_mov_b32 s76, 360448
    s_mov_b32 s77, 393216
    s_mov_b32 s78, 425984
    s_mov_b32 s79, 491520
    s_branch L_tab_done
L_tab1:
    s_cmp_eq_u32 s28, 1
    s_cbranch_scc0 L_tab2
    s_mov_b32 s64, 0
    s_mov_b32 s65, 32768
    s_mov_b32 s66, 163840
    s_mov_b32 s67, 65536
    s_mov_b32 s68, 98304
    s_mov_b32 s69, 131072
    s_mov_b32 s70, 196608
    s_mov_b32 s71, 229376
    s_mov_b32 s72, 360448
    s_mov_b32 s73, 262144
    s_mov_b32 s74, 294912
    s_mov_b32 s75, 327680
    s_mov_b32 s76, 491520
    s_mov_b32 s77, 393216
    s_mov_b32 s78, 425984
    s_mov_b32 s79, 458752
    s_branch L_tab_done
L_tab2:
    s_cmp_eq_u32 s28, 2
    s_cbranch_scc0 L_tab3
    s_mov_b32 s64, 0
    s_mov_b32 s65, 98304
    s_mov_b32 s66, 32768
    s_mov_b32 s67, 65536
    s_mov_b32 s68, 196608
    s_mov_b32 s69, 131072
    s_mov_b32 s70, 163840
    s_mov_b32 s71, 294912
    s_mov_b32 s72, 229376
    s_mov_b32 s73, 262144
    s_mov_b32 s74, 393216
    s_mov_b32 s75, 327680
    s_mov_b32 s76, 360448
    s_mov_b32 s77, 425984
    s_mov_b32 s78, 458752
    s_mov_b32 s79, 491520
    s_branch L_tab_done
L_tab3:
    s_mov_b32 s64, 0
    s_mov_b32 s65, 32768
    s_mov_b32 s66, 131072
    s_mov_b32 s67, 65536
    s_mov_b32 s68, 98304
    s_mov_b32 s69, 229376
    s_mov_b32 s70, 163840
    s_mov_b32 s71, 196608
    s_mov_b32 s72, 327680
    s_mov_b32 s73, 262144
    s_mov_b32 s74, 294912
    s_mov_b32 s75, 425984
    s_mov_b32 s76, 360448
    s_mov_b32 s77, 393216
    s_mov_b32 s78, 458752
    s_mov_b32 s79, 491520
L_tab_done:
    s_mov_b32 s80, 0x40000000
    s_mov_b32 s81, 0x40000000
    s_mov_b32 s82, 0x40000000
    s_mov_b32 s83, 0x40000000
    s_mov_b32 s32, 0x3db8aa3b
    s_mov_b32 s33, 0x45800000
    v_and_b32 v108, 15, v100
    s_waitcnt lgkmcnt(0)
    s_add_u32 s20, s8, s37
    s_addc_u32 s21, s9, 0
    s_mov_b32 s22, 524288
    s_mov_b32 s23, 0x20000
    s_add_u32 s24, s10, s36
    s_addc_u32 s25, s11, 0
    s_mov_b32 s26, s14
    s_mov_b32 s27, 0x20000
    s_cmp_ge_u32 s41, 4
    s_cbranch_scc1 L_roleB
    v_mov_b32 v4, v114
    v_mov_b32 v5, v115
    v_lshlrev_b32 v109, 7, v108
    v_and_b32 v110, 6, v108
    v_or_b32 v111, 0, v107
    v_xor_b32 v111, v111, v110
    v_lshl_add_u32 v112, v111, 4, v109
    v_add_u32 v6, s31, v112
    v_or_b32 v111, 4, v107
    v_xor_b32 v111, v111, v110
    v_lshl_add_u32 v113, v111, 4, v109
    v_add_u32 v7, s31, v113
    v_add_u32 v13, 24576, v112
    v_add_u32 v14, 24576, v113
    v_add_u32 v15, 57344, v112
    v_add_u32 v16, 57344, v113
    v_add_u32 v17, 90112, v112
    v_add_u32 v23, 90112, v113
    v_add_u32 v24, 122880, v112
    v_add_u32 v25, 122880, v113
    v_add_u32 v26, 131072, v112
    v_add_u32 v27, 131072, v113
    v_lshlrev_b32 v109, 4, v100
    v_lshrrev_b32 v110, 1, v102
    v_lshlrev_b32 v110, 10, v110
    v_and_b32 v111, 1, v102
    v_lshlrev_b32 v111, 3, v111
    v_add3_u32 v8, v109, v110, v111
    v_add_u32 v8, 131072, v8
    v_and_b32 v109, 7, v100
    v_lshlrev_b32 v110, 2, v109
    v_add_u32 v9, 154112, v110
    v_lshrrev_b32 v113, 2, v109
    v_lshlrev_b32 v110, 2, v102
    v_add_u32 v10, 154112, v110
    v_mov_b32 v12, 1
    s_mov_b32 s39, 0
    v_mbcnt_lo_u32_b32 v11, -1, 0
    v_mbcnt_hi_u32_b32 v11, -1, v11
    v_and_b32 v11, 15, v11
    v_lshlrev_b32 v11, 4, v11
    v_add_u32 v11, 151552, v11
    s_lshl_b32 s40, s30, 2
    v_add_u32 v11, s40, v11
    v_mov_b32 v109, 0xff800000
    v_mov_b32 v110, 0
    ds_write_b32 v11, v109 offset:0
    ds_write_b32 v11, v109 offset:256
    ds_write_b32 v11, v109 offset:512
    ds_write_b32 v11, v109 offset:768
    ds_write_b32 v11, v109 offset:1024
    ds_write_b32 v11, v109 offset:1280
    ds_write_b32 v11, v109 offset:1536
    ds_write_b32 v11, v109 offset:1792
    ds_write_b32 v11, v109 offset:2048
    ds_write_b32 v11, v109 offset:2304
    ds_write_b32 v9, v113 offset:0
    ds_write_b32 v9, v110 offset:32
    v_mbcnt_lo_u32_b32 v111, -1, 0
    v_mbcnt_hi_u32_b32 v111, -1, v111
    v_lshlrev_b32 v111, 2, v111
    s_mul_i32 s40, s30, 1280
    s_add_u32 s40, s40, 155648
    v_add_u32 v111, s40, v111
    ds_write_b32 v111, v110 offset:0
    ds_write_b32 v111, v110 offset:256
    ds_write_b32 v111, v110 offset:512
    ds_write_b32 v111, v110 offset:768
    ds_write_b32 v111, v110 offset:1024
    ds_write_b32 v10, v110 offset:64
    ds_write_b32 v10, v110 offset:80
    ds_write_b32 v10, v110 offset:96
    s_mov_b32 s35, 0
    s_add_u32 m0, s31, 1920
    s_nop 0
    buffer_load_dwordx4 v4, s[16:19], s35 offen offset:128  lds
    buffer_load_dwordx4 v5, s[16:19], s35 offen offset:1152  lds
    s_add_u32 m0, s31, 3840
    s_nop 0
    buffer_load_dwordx4 v4, s[16:19], s35 offen offset:256  lds
    buffer_load_dwordx4 v5, s[16:19], s35 offen offset:1280  lds
    s_add_u32 m0, s31, 5760
    s_nop 0
    buffer_load_dwordx4 v4, s[16:19], s35 offen offset:384  lds
    buffer_load_dwordx4 v5, s[16:19], s35 offen offset:1408  lds
    s_mov_b32 s34, 2
    s_waitcnt vmcnt(8) lgkmcnt(0)
    s_barrier
    s_cmp_ge_u32 s28, 2
    s_cbranch_scc1 L_roleA4
    ds_read_b128 v[64:67], v13 offset:0
    ds_read_b128 v[68:71], v14 offset:0
    ds_read_b128 v[72:75], v13 offset:2048
    ds_read_b128 v[76:79], v14 offset:2048
    ds_read_b128 v[80:83], v13 offset:4096
    ds_read_b128 v[84:87], v14 offset:4096
    ds_read_b128 v[88:91], v13 offset:6144
    ds_read_b128 v[92:95], v14 offset:6144
    ds_read_b128 v[96:99], v15 offset:0
    ds_read_b128 v[100:103], v16 offset:0
    ds_read_b128 v[104:107], v15 offset:2048
    ds_read_b128 v[108:111], v16 offset:2048
    ds_read_b128 v[112:115], v15 offset:4096
    ds_read_b128 v[116:119], v16 offset:4096
    ds_read_b128 v[120:123], v15 offset:6144
    ds_read_b128 v[124:127], v16 offset:6144
    s_waitcnt vmcnt(0)
    ds_read_b128 a[96:99], v6 offset:0
    ds_read_b128 a[100:103], v7 offset:0
    ds_read_b128 a[104:107], v6 offset:2048
    ds_read_b128 a[108:111], v7 offset:2048
    ds_read_b128 a[112:115], v6 offset:4096
    ds_read_b128 a[116:119], v7 offset:4096
    ds_read_b128 a[120:123], v6 offset:6144
    ds_read_b128 a[124:127], v7 offset:6144
    s_waitcnt lgkmcnt(7)
    v_mfma_f32_16x16x32_bf16 v[40:43], a[96:99], v[64:67], 0
    ds_read_b128 a[0:3], v17 offset:0
    ds_read_b128 a[4:7], v23 offset:0
    ds_read_b128 a[8:11], v17 offset:2048
    s_waitcnt lgkmcnt(9)
    v_mfma_f32_16x16x32_bf16 v[40:43], a[100:103], v[68:71], v[40:43]
    ds_read_b128 a[12:15], v23 offset:2048
    ds_read_b128 a[16:19], v17 offset:4096
    s_waitcnt lgkmcnt(10)
    v_mfma_f32_16x16x32_bf16 v[40:43], a[104:107], v[72:75], v[40:43]
    ds_read_b128 a[20:23], v23 offset:4096
    ds_read_b128 a[24:27], v17 offset:6144
    s_waitcnt lgkmcnt(11)
    v_mfma_f32_16x16x32_bf16 v[40:43], a[108:111], v[76:79], v[40:43]
    ds_read_b128 a[28:31], v23 offset:6144
    ds_read_b128 a[32:35], v24 offset:0
    s_waitcnt lgkmcnt(12)
    v_mfma_f32_16x16x32_bf16 v[40:43], a[112:115], v[80:83], v[40:43]
    ds_read_b128 a[36:39], v25 offset:0
    ds_read_b128 a[40:43], v24 offset:2048
    s_waitcnt lgkmcnt(13)
    v_mfma_f32_16x16x32_bf16 v[40:43], a[116:119], v[84:87], v[40:43]
    ds_read_b128 a[44:47], v25 offset:2048
    ds_read_b128 a[48:51], v24 offset:4096
    ds_read_b128 a[52:55], v25 offset:4096
    s_waitcnt lgkmcnt(15)
    v_mfma_f32_16x16x32_bf16 v[40:43], a[120:123], v[88:91], v[40:43]
    ds_read_b128 a[56:59], v24 offset:6144
    ds_read_b128 a[60:63], v25 offset:6144
    s_waitcnt lgkmcnt(15)
    v_mfma_f32_16x16x32_bf16 v[40:43], a[124:127], v[92:95], v[40:43]
    ds_read_b128 a[64:67], v26 offset:0
    ds_read_b128 a[68:71], v27 offset:0
    v_mfma_f32_16x16x32_bf16 v[48:51], a[96:99], v[96:99], 0
    ds_read_b128 a[72:75], v26 offset:2048
    ds_read_b128 a[76:79], v27 offset:2048
    v_mfma_f32_16x16x32_bf16 v[48:51], a[100:103], v[100:103], v[48:51]
    ds_read_b128 a[80:83], v26 offset:4096
    ds_read_b128 a[84:87], v27 offset:4096
    v_mfma_f32_16x16x32_bf16 v[48:51], a[104:107], v[104:107], v[48:51]
    ds_read_b128 a[88:91], v26 offset:6144
    ds_read_b128 a[92:95], v27 offset:6144
    v_max3_f32 v28, v40, v41, v42
    v_max_f32 v28, v28, v43
    v_mfma_f32_16x16x32_bf16 v[48:51], a[108:111], v[108:111], v[48:51]
    ds_write_b32 v10, v12 offset:64
    v_mov_b32 v29, v28
    s_nop 1
    v_permlane16_swap_b32 v28, v29
    v_mfma_f32_16x16x32_bf16 v[48:51], a[112:115], v[112:115], v[48:51]
    s_nop 0
    v_max_f32 v28, v28, v29
    v_mfma_f32_16x16x32_bf16 v[48:51], a[116:119], v[116:119], v[48:51]
    v_mov_b32 v29, v28
    v_mfma_f32_16x16x32_bf16 v[48:51], a[120:123], v[120:123], v[48:51]
    s_nop 0
    v_permlane32_swap_b32 v28, v29
    s_nop 0
    v_mfma_f32_16x16x32_bf16 v[48:51], a[124:127], v[124:127], v[48:51]
    v_max_f32 v28, v28, v29
    v_mul_f32 v28, s32, v28
    v_mfma_f32_16x16x32_bf16 v[52:55], a[96:99], a[0:3], 0
    v_ceil_f32 v28, v28
    s_waitcnt lgkmcnt(15)
    v_mfma_f32_16x16x32_bf16 v[52:55], a[100:103], a[4:7], v[52:55]
    ds_write_b32 v11, v28 offset:2816
    v_mfma_f32_16x16x32_bf16 v[52:55], a[104:107], a[8:11], v[52:55]
    v_max3_f32 v32, v48, v49, v50
    v_max_f32 v32, v32, v51
    v_mfma_f32_16x16x32_bf16 v[52:55], a[108:111], a[12:15], v[52:55]
    v_mov_b32 v33, v32
    s_nop 1
    v_permlane16_swap_b32 v32, v33
    v_mfma_f32_16x16x32_bf16 v[52:55], a[112:115], a[16:19], v[52:55]
    s_nop 0
    v_max_f32 v32, v32, v33
    v_mfma_f32_16x16x32_bf16 v[52:55], a[116:119], a[20:23], v[52:55]
    v_mov_b32 v33, v32
    v_mfma_f32_16x16x32_bf16 v[52:55], a[120:123], a[24:27], v[52:55]
    s_nop 0
    v_permlane32_swap_b32 v32, v33
    s_nop 0
    v_mfma_f32_16x16x32_bf16 v[52:55], a[124:127], a[28:31], v[52:55]
    v_max_f32 v32, v32, v33
    v_mul_f32 v32, s32, v32
    v_mfma_f32_16x16x32_bf16 v[56:59], a[96:99], a[32:35], 0
    v_ceil_f32 v32, v32
    v_mfma_f32_16x16x32_bf16 v[56:59], a[100:103], a[36:39], v[56:59]
    ds_write_b32 v11, v32 offset:3072
    s_waitcnt lgkmcnt(15)
    v_mfma_f32_16x16x32_bf16 v[56:59], a[104:107], a[40:43], v[56:59]
    v_max3_f32 v28, v52, v53, v54
    v_max_f32 v28, v28, v55
    v_mfma_f32_16x16x32_bf16 v[56:59], a[108:111], a[44:47], v[56:59]
    v_mov_b32 v29, v28
    s_nop 1
    v_permlane16_swap_b32 v28, v29
    s_waitcnt lgkmcnt(14)
    v_mfma_f32_16x16x32_bf16 v[56:59], a[112:115], a[48:51], v[56:59]
    s_nop 0
    v_max_f32 v28, v28, v29
    s_waitcnt lgkmcnt(13)
    v_mfma_f32_16x16x32_bf16 v[56:59], a[116:119], a[52:55], v[56:59]
    v_mov_b32 v29, v28
    s_waitcnt lgkmcnt(12)
    v_mfma_f32_16x16x32_bf16 v[56:59], a[120:123], a[56:59], v[56:59]
    v_permlane32_swap_b32 v28, v29
    s_nop 0
    s_waitcnt lgkmcnt(11)
    v_mfma_f32_16x16x32_bf16 v[56:59], a[124:127], a[60:63], v[56:59]
    v_max_f32 v28, v28, v29
    v_mul_f32 v28, s32, v28
    s_waitcnt lgkmcnt(10)
    v_mfma_f32_16x16x32_bf16 v[60:63], a[96:99], a[64:67], 0
    v_ceil_f32 v28, v28
    s_waitcnt lgkmcnt(9)
    v_mfma_f32_16x16x32_bf16 v[60:63], a[100:103], a[68:71], v[60:63]
    ds_write_b32 v11, v28 offset:3328
    s_waitcnt lgkmcnt(9)
    v_mfma_f32_16x16x32_bf16 v[60:63], a[104:107], a[72:75], v[60:63]
    v_max3_f32 v32, v56, v57, v58
    v_max_f32 v32, v32, v59
    v_mov_b32 v33, v32
    s_waitcnt lgkmcnt(8)
    v_mfma_f32_16x16x32_bf16 v[60:63], a[108:111], a[76:79], v[60:63]
    v_permlane16_swap_b32 v32, v33
    s_nop 0
    s_waitcnt lgkmcnt(7)
    v_mfma_f32_16x16x32_bf16 v[60:63], a[112:115], a[80:83], v[60:63]
    v_max_f32 v32, v32, v33
    v_mov_b32 v33, v32
    s_nop 1
    v_permlane32_swap_b32 v32, v33
    s_waitcnt lgkmcnt(6)
    v_mfma_f32_16x16x32_bf16 v[60:63], a[116:119], a[84:87], v[60:63]
    s_nop 0
    v_max_f32 v32, v32, v33
    s_waitcnt lgkmcnt(5)
    v_mfma_f32_16x16x32_bf16 v[60:63], a[120:123], a[88:91], v[60:63]
    v_mul_f32 v32, s32, v32
    v_ceil_f32 v32, v32
    s_waitcnt lgkmcnt(4)
    v_mfma_f32_16x16x32_bf16 v[60:63], a[124:127], a[92:95], v[60:63]
    ds_write_b32 v11, v32 offset:3584
    s_nop 6
    v_max3_f32 v28, v60, v61, v62
    v_max_f32 v28, v28, v63
    v_mov_b32 v29, v28
    s_nop 1
    v_permlane16_swap_b32 v28, v29
    s_nop 0
    v_max_f32 v28, v28, v29
    v_mov_b32 v29, v28
    s_nop 1
    v_permlane32_swap_b32 v28, v29
    s_nop 0
    v_max_f32 v28, v28, v29
    v_mul_f32 v28, s32, v28
    v_ceil_f32 v28, v28
    ds_write_b32 v11, v28 offset:3840
    ds_write_b32 v10, v12 offset:80
    s_lshl_b32 s40, s30, 2
    v_subrev_u32 v11, s40, v11
L_mpoll_5:
    ds_read_b32 v36, v9 offset:64
    s_waitcnt lgkmcnt(0)
    v_cmp_ne_u32 vcc, 1, v36
    s_cbranch_vccnz L_mpoll_5
    ds_read_b128 v[28:31], v11 offset:2816
    ds_read_b128 v[32:35], v11 offset:3072
    ds_read_b128 v[36:39], v11 offset:3328
    ds_read_b128 v[44:47], v11 offset:3584
    ds_read_b128 v[18:21], v11 offset:3840
    s_waitcnt lgkmcnt(4)
    v_max3_f32 v28, v28, v29, v30
    v_max_f32 v13, v28, v31
    s_waitcnt lgkmcnt(3)
    v_max3_f32 v32, v32, v33, v34
    v_max_f32 v14, v32, v35
    s_waitcnt lgkmcnt(2)
    v_max3_f32 v36, v36, v37, v38
    v_max_f32 v15, v36, v39
    s_waitcnt lgkmcnt(1)
    v_max3_f32 v44, v44, v45, v46
    v_max_f32 v16, v44, v47
    s_waitcnt lgkmcnt(0)
    v_max3_f32 v18, v18, v19, v20
    v_max_f32 v17, v18, v21
    v_mov_b32 v18, 0
    v_mov_b32 v19, 0
    v_mov_b32 v20, 0
    v_mov_b32 v21, 0
    v_mov_b32 v22, 0
    ds_read_b32 v11, v10 offset:96
    v_fma_f32 v28, v40, s32, -v13
    v_fma_f32 v29, v41, s32, -v13
    v_fma_f32 v30, v42, s32, -v13
    v_fma_f32 v31, v43, s32, -v13
    v_exp_f32 v28, v28
    v_exp_f32 v29, v29
    v_exp_f32 v30, v30
    v_exp_f32 v31, v31
    v_cvt_pk_bf16_f32 v0, v28, v29
    v_add_f32 v23, v28, v29
    v_cvt_pk_bf16_f32 v1, v30, v31
    v_add_f32 v30, v30, v31
    v_add_f32 v23, v23, v30
    v_fma_f32 v32, v48, s32, -v14
    v_fma_f32 v33, v49, s32, -v14
    v_fma_f32 v34, v50, s32, -v14
    v_fma_f32 v35, v51, s32, -v14
    v_exp_f32 v32, v32
    v_exp_f32 v33, v33
    v_exp_f32 v34, v34
    v_exp_f32 v35, v35
    v_cvt_pk_bf16_f32 v2, v32, v33
    v_add_f32 v24, v32, v33
    v_cvt_pk_bf16_f32 v3, v34, v35
    v_add_f32 v34, v34, v35
    v_add_f32 v24, v24, v34
L_k1poll_5:
    s_waitcnt lgkmcnt(0)
    v_cmp_ne_u32 vcc, 1, v11
    s_cbranch_vccz L_k1ok_5
    ds_read_b32 v11, v10 offset:96
    s_waitcnt lgkmcnt(0)
    s_branch L_k1poll_5
L_k1ok_5:
    ds_read_b128 a[96:99], v6 offset:8192
    ds_read_b128 a[100:103], v7 offset:8192
    ds_read_b128 a[104:107], v6 offset:10240
    ds_read_b128 a[108:111], v7 offset:10240
    ds_read_b128 a[112:115], v6 offset:12288
    ds_read_b128 a[116:119], v7 offset:12288
    ds_read_b128 a[120:123], v6 offset:14336
    ds_read_b128 a[124:127], v7 offset:14336
    v_fma_f32 v28, v52, s32, -v15
    v_fma_f32 v29, v53, s32, -v15
    v_fma_f32 v30, v54, s32, -v15
    v_fma_f32 v31, v55, s32, -v15
    v_exp_f32 v28, v28
    v_exp_f32 v29, v29
    v_exp_f32 v30, v30
    v_exp_f32 v31, v31
    v_cvt_pk_bf16_f32 v36, v28, v29
    v_add_f32 v25, v28, v29
    v_cvt_pk_bf16_f32 v37, v30, v31
    v_add_f32 v30, v30, v31
    v_add_f32 v25, v25, v30
    v_fma_f32 v32, v56, s32, -v16
    v_fma_f32 v33, v57, s32, -v16
    v_fma_f32 v34, v58, s32, -v16
    v_fma_f32 v35, v59, s32, -v16
    v_exp_f32 v32, v32
    v_exp_f32 v33, v33
    v_exp_f32 v34, v34
    v_exp_f32 v35, v35
    v_cvt_pk_bf16_f32 v38, v32, v33
    v_add_f32 v26, v32, v33
    v_cvt_pk_bf16_f32 v39, v34, v35
    s_mov_b32 m0, s34
    s_add_u32 s34, s34, 1
    s_movrels_b32 s35, s64
    s_add_u32 m0, s31, 0
    s_nop 0
    buffer_load_dwordx4 v4, s[16:19], s35 offen offset:0  lds
    buffer_load_dwordx4 v5, s[16:19], s35 offen offset:1024  lds
    s_add_u32 m0, s31, 1920
    s_nop 0
    buffer_load_dwordx4 v4, s[16:19], s35 offen offset:128  lds
    s_waitcnt lgkmcnt(0)
    s_nop 7
    s_mov_b32 s38, 0
.p2align 3
L_loopA_5:
    s_waitcnt lgkmcnt(7)
    v_mfma_f32_16x16x32_bf16 v[44:47], a[96:99], v[64:67], 0
    v_add_f32 v34, v34, v35
    v_add_f32 v26, v26, v34
    s_waitcnt lgkmcnt(6)
    v_mfma_f32_16x16x32_bf16 v[44:47], a[100:103], v[68:71], v[44:47]
    ds_read_b32 v11, v9 offset:32
    v_fma_f32 v28, v60, s32, -v17
    v_fma_f32 v29, v61, s32, -v17
    s_waitcnt lgkmcnt(6)
    v_mfma_f32_16x16x32_bf16 v[44:47], a[104:107], v[72:75], v[44:47]
    v_fma_f32 v30, v62, s32, -v17
    v_fma_f32 v31, v63, s32, -v17
    buffer_load_dwordx4 v5, s[16:19], s35 offen offset:1152  lds
    s_waitcnt lgkmcnt(5)
    v_mfma_f32_16x16x32_bf16 v[44:47], a[108:111], v[76:79], v[44:47]
    v_exp_f32 v28, v28
    v_exp_f32 v29, v29
    s_waitcnt lgkmcnt(4)
    v_mfma_f32_16x16x32_bf16 v[44:47], a[112:115], v[80:83], v[44:47]
    v_exp_f32 v30, v30
    v_exp_f32 v31, v31
    v_cvt_pk_bf16_f32 v34, v28, v29
    s_waitcnt lgkmcnt(3)
    v_mfma_f32_16x16x32_bf16 v[44:47], a[116:119], v[84:87], v[44:47]
    v_add_f32 v27, v28, v29
    v_cvt_pk_bf16_f32 v35, v30, v31
    s_add_u32 m0, s31, 3840
    s_waitcnt lgkmcnt(2)
    v_mfma_f32_16x16x32_bf16 v[44:47], a[120:123], v[88:91], v[44:47]
    v_add_f32 v30, v30, v31
    v_add_f32 v27, v27, v30
    buffer_load_dwordx4 v4, s[16:19], s35 offen offset:256  lds
    s_waitcnt lgkmcnt(1)
    v_mfma_f32_16x16x32_bf16 v[44:47], a[124:127], v[92:95], v[44:47]
    s_waitcnt lgkmcnt(0)
    v_cmp_ne_u32 vcc, s39, v11
    s_cbranch_vccnz L_slowca3
L_retca3:
    v_max3_f32 v32, v23, v24, v25
    v_max3_f32 v32, v32, v26, v27
    s_add_u32 s39, s39, 1
    v_cmp_lt_f32 vcc, s33, v32
    v_mov_b32 v12, s39
    s_cbranch_vccnz L_slowp3
L_retp3:
    ds_write2st64_b64 v8, v[0:1], v[2:3] offset0:0 offset1:4
    ds_write2st64_b64 v8, v[36:37], v[38:39] offset0:8 offset1:12
    ds_write_b64 v8, v[34:35] offset:8192
    ds_write_b32 v10, v12 offset:0
    v_mfma_f32_16x16x32_bf16 v[48:51], a[96:99], v[96:99], 0
    v_add_f32 v18, v18, v23
    v_add_f32 v19, v19, v24
    v_mfma_f32_16x16x32_bf16 v[48:51], a[100:103], v[100:103], v[48:51]
    v_add_f32 v20, v20, v25
    v_add_f32 v21, v21, v26
    v_mfma_f32_16x16x32_bf16 v[48:51], a[104:107], v[104:107], v[48:51]
    v_add_f32 v22, v22, v27
    v_fma_f32 v28, v44, s32, -v13
    v_fma_f32 v29, v45, s32, -v13
    buffer_load_dwordx4 v5, s[16:19], s35 offen offset:1280  lds
    v_mfma_f32_16x16x32_bf16 v[48:51], a[108:111], v[108:111], v[48:51]
    v_fma_f32 v30, v46, s32, -v13
    v_fma_f32 v31, v47, s32, -v13
    v_mfma_f32_16x16x32_bf16 v[48:51], a[112:115], v[112:115], v[48:51]
    v_exp_f32 v28, v28
    v_exp_f32 v29, v29
    v_mfma_f32_16x16x32_bf16 v[48:51], a[116:119], v[116:119], v[48:51]
    v_exp_f32 v30, v30
    v_exp_f32 v31, v31
    s_add_u32 m0, s31, 5760
    v_mfma_f32_16x16x32_bf16 v[48:51], a[120:123], v[120:123], v[48:51]
    v_cvt_pk_bf16_f32 v0, v28, v29
    v_add_f32 v23, v28, v29
    buffer_load_dwordx4 v4, s[16:19], s35 offen offset:384  lds
    v_mfma_f32_16x16x32_bf16 v[48:51], a[124:127], v[124:127], v[48:51]
    v_cvt_pk_bf16_f32 v1, v30, v31
    v_add_f32 v30, v30, v31
    v_mfma_f32_16x16x32_bf16 v[52:55], a[96:99], a[0:3], 0
    v_add_f32 v23, v23, v30
    v_mfma_f32_16x16x32_bf16 v[52:55], a[100:103], a[4:7], v[52:55]
    s_nop 2
    v_fma_f32 v32, v48, s32, -v14
    v_fma_f32 v33, v49, s32, -v14
    v_mfma_f32_16x16x32_bf16 v[52:55], a[104:107], a[8:11], v[52:55]
    v_fma_f32 v34, v50, s32, -v14
    v_fma_f32 v35, v51, s32, -v14
    buffer_load_dwordx4 v5, s[16:19], s35 offen offset:1408  lds
    v_mfma_f32_16x16x32_bf16 v[52:55], a[108:111], a[12:15], v[52:55]
    v_exp_f32 v32, v32
    v_exp_f32 v33, v33
    v_mfma_f32_16x16x32_bf16 v[52:55], a[112:115], a[16:19], v[52:55]
    v_exp_f32 v34, v34
    v_mfma_f32_16x16x32_bf16 v[52:55], a[116:119], a[20:23], v[52:55]
    v_exp_f32 v35, v35
    v_cvt_pk_bf16_f32 v2, v32, v33
    v_mfma_f32_16x16x32_bf16 v[52:55], a[120:123], a[24:27], v[52:55]
    v_add_f32 v24, v32, v33
    v_cvt_pk_bf16_f32 v3, v34, v35
    v_mfma_f32_16x16x32_bf16 v[52:55], a[124:127], a[28:31], v[52:55]
    v_add_f32 v34, v34, v35
    v_mfma_f32_16x16x32_bf16 v[56:59], a[96:99], a[32:35], 0
    v_add_f32 v24, v24, v34
    v_mfma_f32_16x16x32_bf16 v[56:59], a[100:103], a[36:39], v[56:59]
    s_nop 3
    v_fma_f32 v28, v52, s32, -v15
    v_fma_f32 v29, v53, s32, -v15
    v_mfma_f32_16x16x32_bf16 v[56:59], a[104:107], a[40:43], v[56:59]
    v_fma_f32 v30, v54, s32, -v15
    v_fma_f32 v31, v55, s32, -v15
    s_mov_b32 m0, s34
    v_mfma_f32_16x16x32_bf16 v[56:59], a[108:111], a[44:47], v[56:59]
    v_exp_f32 v28, v28
    v_exp_f32 v29, v29
    s_add_u32 s34, s34, 1
    v_mfma_f32_16x16x32_bf16 v[56:59], a[112:115], a[48:51], v[56:59]
    v_exp_f32 v30, v30
    s_movrels_b32 s35, s64
    v_mfma_f32_16x16x32_bf16 v[56:59], a[116:119], a[52:55], v[56:59]
    v_exp_f32 v31, v31
    v_cvt_pk_bf16_f32 v36, v28, v29
    s_add_u32 m0, s31, 8192
    v_mfma_f32_16x16x32_bf16 v[56:59], a[120:123], a[56:59], v[56:59]
    v_add_f32 v25, v28, v29
    v_cvt_pk_bf16_f32 v37, v30, v31
    buffer_load_dwordx4 v4, s[16:19], s35 offen offset:0  lds
    v_mfma_f32_16x16x32_bf16 v[56:59], a[124:127], a[60:63], v[56:59]
    v_add_f32 v30, v30, v31
    v_mfma_f32_16x16x32_bf16 v[60:63], a[96:99], a[64:67], 0
    s_waitcnt vmcnt(1)
    ds_read_b128 a[96:99], v6 offset:0
    v_add_f32 v25, v25, v30
    v_mfma_f32_16x16x32_bf16 v[60:63], a[100:103], a[68:71], v[60:63]
    ds_read_b128 a[100:103], v7 offset:0
    s_nop 0
    v_fma_f32 v32, v56, s32, -v16
    v_fma_f32 v33, v57, s32, -v16
    v_mfma_f32_16x16x32_bf16 v[60:63], a[104:107], a[72:75], v[60:63]
    ds_read_b128 a[104:107], v6 offset:2048
    v_fma_f32 v34, v58, s32, -v16
    v_fma_f32 v35, v59, s32, -v16
    buffer_load_dwordx4 v5, s[16:19], s35 offen offset:1024  lds
    v_mfma_f32_16x16x32_bf16 v[60:63], a[108:111], a[76:79], v[60:63]
    ds_read_b128 a[108:111], v7 offset:2048
    v_exp_f32 v32, v32
    v_mfma_f32_16x16x32_bf16 v[60:63], a[112:115], a[80:83], v[60:63]
    ds_read_b128 a[112:115], v6 offset:4096
    v_exp_f32 v33, v33
    v_exp_f32 v34, v34
    v_mfma_f32_16x16x32_bf16 v[60:63], a[116:119], a[84:87], v[60:63]
    ds_read_b128 a[116:119], v7 offset:4096
    v_exp_f32 v35, v35
    v_cvt_pk_bf16_f32 v38, v32, v33
    s_add_u32 m0, s31, 10112
    v_mfma_f32_16x16x32_bf16 v[60:63], a[120:123], a[88:91], v[60:63]
    ds_read_b128 a[120:123], v6 offset:6144
    v_add_f32 v26, v32, v33
    buffer_load_dwordx4 v4, s[16:19], s35 offen offset:128  lds
    v_mfma_f32_16x16x32_bf16 v[60:63], a[124:127], a[92:95], v[60:63]
    ds_read_b128 a[124:127], v7 offset:6144
    v_cvt_pk_bf16_f32 v39, v34, v35
    s_cmp_eq_u32 s38, 7
    s_cbranch_scc1 L_epA_5
    s_waitcnt lgkmcnt(7)
    v_mfma_f32_16x16x32_bf16 v[40:43], a[96:99], v[64:67], 0
    v_add_f32 v34, v34, v35
    v_add_f32 v26, v26, v34
    s_waitcnt lgkmcnt(6)
    v_mfma_f32_16x16x32_bf16 v[40:43], a[100:103], v[68:71], v[40:43]
    ds_read_b32 v11, v9 offset:0
    v_fma_f32 v28, v60, s32, -v17
    v_fma_f32 v29, v61, s32, -v17
    s_waitcnt lgkmcnt(6)
    v_mfma_f32_16x16x32_bf16 v[40:43], a[104:107], v[72:75], v[40:43]
    v_fma_f32 v30, v62, s32, -v17
    v_fma_f32 v31, v63, s32, -v17
    buffer_load_dwordx4 v5, s[16:19], s35 offen offset:1152  lds
    s_waitcnt lgkmcnt(5)
    v_mfma_f32_16x16x32_bf16 v[40:43], a[108:111], v[76:79], v[40:43]
    v_exp_f32 v28, v28
    v_exp_f32 v29, v29
    s_waitcnt lgkmcnt(4)
    v_mfma_f32_16x16x32_bf16 v[40:43], a[112:115], v[80:83], v[40:43]
    v_exp_f32 v30, v30
    v_exp_f32 v31, v31
    v_cvt_pk_bf16_f32 v34, v28, v29
    s_waitcnt lgkmcnt(3)
    v_mfma_f32_16x16x32_bf16 v[40:43], a[116:119], v[84:87], v[40:43]
    v_add_f32 v27, v28, v29
    v_cvt_pk_bf16_f32 v35, v30, v31
    s_add_u32 m0, s31, 12032
    s_waitcnt lgkmcnt(2)
    v_mfma_f32_16x16x32_bf16 v[40:43], a[120:123], v[88:91], v[40:43]
    v_add_f32 v30, v30, v31
    v_add_f32 v27, v27, v30
    buffer_load_dwordx4 v4, s[16:19], s35 offen offset:256  lds
    s_waitcnt lgkmcnt(1)
    v_mfma_f32_16x16x32_bf16 v[40:43], a[124:127], v[92:95], v[40:43]
    s_waitcnt lgkmcnt(0)
    v_cmp_ne_u32 vcc, s39, v11
    s_cbranch_vccnz L_slowca4
L_retca4:
    v_max3_f32 v32, v23, v24, v25
    v_max3_f32 v32, v32, v26, v27
    s_add_u32 s39, s39, 1
    v_cmp_lt_f32 vcc, s33, v32
    v_mov_b32 v12, s39
    s_cbranch_vccnz L_slowp4
L_retp4:
    ds_write2st64_b64 v8, v[0:1], v[2:3] offset0:20 offset1:24
    ds_write2st64_b64 v8, v[36:37], v[38:39] offset0:28 offset1:32
    ds_write_b64 v8, v[34:35] offset:18432
    ds_write_b32 v10, v12 offset:32
    v_mfma_f32_16x16x32_bf16 v[48:51], a[96:99], v[96:99], 0
    v_add_f32 v18, v18, v23
    v_add_f32 v19, v19, v24
    v_mfma_f32_16x16x32_bf16 v[48:51], a[100:103], v[100:103], v[48:51]
    v_add_f32 v20, v20, v25
    v_add_f32 v21, v21, v26
    v_mfma_f32_16x16x32_bf16 v[48:51], a[104:107], v[104:107], v[48:51]
    v_add_f32 v22, v22, v27
    v_fma_f32 v28, v40, s32, -v13
    v_fma_f32 v29, v41, s32, -v13
    buffer_load_dwordx4 v5, s[16:19], s35 offen offset:1280  lds
    v_mfma_f32_16x16x32_bf16 v[48:51], a[108:111], v[108:111], v[48:51]
    v_fma_f32 v30, v42, s32, -v13
    v_fma_f32 v31, v43, s32, -v13
    v_mfma_f32_16x16x32_bf16 v[48:51], a[112:115], v[112:115], v[48:51]
    v_exp_f32 v28, v28
    v_exp_f32 v29, v29
    v_mfma_f32_16x16x32_bf16 v[48:51], a[116:119], v[116:119], v[48:51]
    v_exp_f32 v30, v30
    v_exp_f32 v31, v31
    s_add_u32 m0, s31, 13952
    v_mfma_f32_16x16x32_bf16 v[48:51], a[120:123], v[120:123], v[48:51]
    v_cvt_pk_bf16_f32 v0, v28, v29
    v_add_f32 v23, v28, v29
    buffer_load_dwordx4 v4, s[16:19], s35 offen offset:384  lds
    v_mfma_f32_16x16x32_bf16 v[48:51], a[124:127], v[124:127], v[48:51]
    v_cvt_pk_bf16_f32 v1, v30, v31
    v_add_f32 v30, v30, v31
    v_mfma_f32_16x16x32_bf16 v[52:55], a[96:99], a[0:3], 0
    v_add_f32 v23, v23, v30
    v_mfma_f32_16x16x32_bf16 v[52:55], a[100:103], a[4:7], v[52:55]
    s_nop 2
    v_fma_f32 v32, v48, s32, -v14
    v_fma_f32 v33, v49, s32, -v14
    v_mfma_f32_16x16x32_bf16 v[52:55], a[104:107], a[8:11], v[52:55]
    v_fma_f32 v34, v50, s32, -v14
    v_fma_f32 v35, v51, s32, -v14
    buffer_load_dwordx4 v5, s[16:19], s35 offen offset:1408  lds
    v_mfma_f32_16x16x32_bf16 v[52:55], a[108:111], a[12:15], v[52:55]
    v_exp_f32 v32, v32
    v_exp_f32 v33, v33
    v_mfma_f32_16x16x32_bf16 v[52:55], a[112:115], a[16:19], v[52:55]
    v_exp_f32 v34, v34
    v_mfma_f32_16x16x32_bf16 v[52:55], a[116:119], a[20:23], v[52:55]
    v_exp_f32 v35, v35
    v_cvt_pk_bf16_f32 v2, v32, v33
    v_mfma_f32_16x16x32_bf16 v[52:55], a[120:123], a[24:27], v[52:55]
    v_add_f32 v24, v32, v33
    v_cvt_pk_bf16_f32 v3, v34, v35
    v_mfma_f32_16x16x32_bf16 v[52:55], a[124:127], a[28:31], v[52:55]
    v_add_f32 v34, v34, v35
    v_mfma_f32_16x16x32_bf16 v[56:59], a[96:99], a[32:35], 0
    v_add_f32 v24, v24, v34
    v_mfma_f32_16x16x32_bf16 v[56:59], a[100:103], a[36:39], v[56:59]
    s_nop 3
    v_fma_f32 v28, v52, s32, -v15
    v_fma_f32 v29, v53, s32, -v15
    v_mfma_f32_16x16x32_bf16 v[56:59], a[104:107], a[40:43], v[56:59]
    v_fma_f32 v30, v54, s32, -v15
    v_fma_f32 v31, v55, s32, -v15
    s_mov_b32 m0, s34
    v_mfma_f32_16x16x32_bf16 v[56:59], a[108:111], a[44:47], v[56:59]
    v_exp_f32 v28, v28
    v_exp_f32 v29, v29
    s_add_u32 s34, s34, 1
    v_mfma_f32_16x16x32_bf16 v[56:59], a[112:115], a[48:51], v[56:59]
    v_exp_f32 v30, v30
    s_movrels_b32 s35, s64
    v_mfma_f32_16x16x32_bf16 v[56:59], a[116:119], a[52:55], v[56:59]
    v_exp_f32 v31, v31
    v_cvt_pk_bf16_f32 v36, v28, v29
    s_add_u32 m0, s31, 0
    v_mfma_f32_16x16x32_bf16 v[56:59], a[120:123], a[56:59], v[56:59]
    v_add_f32 v25, v28, v29
    v_cvt_pk_bf16_f32 v37, v30, v31
    buffer_load_dwordx4 v4, s[16:19], s35 offen offset:0  lds
    v_mfma_f32_16x16x32_bf16 v[56:59], a[124:127], a[60:63], v[56:59]
    v_add_f32 v30, v30, v31
    v_mfma_f32_16x16x32_bf16 v[60:63], a[96:99], a[64:67], 0
    s_waitcnt vmcnt(1)
    ds_read_b128 a[96:99], v6 offset:8192
    v_add_f32 v25, v25, v30
    v_mfma_f32_16x16x32_bf16 v[60:63], a[100:103], a[68:71], v[60:63]
    ds_read_b128 a[100:103], v7 offset:8192
    s_nop 0
    v_fma_f32 v32, v56, s32, -v16
    v_fma_f32 v33, v57, s32, -v16
    v_mfma_f32_16x16x32_bf16 v[60:63], a[104:107], a[72:75], v[60:63]
    ds_read_b128 a[104:107], v6 offset:10240
    v_fma_f32 v34, v58, s32, -v16
    v_fma_f32 v35, v59, s32, -v16
    buffer_load_dwordx4 v5, s[16:19], s35 offen offset:1024  lds
    v_mfma_f32_16x16x32_bf16 v[60:63], a[108:111], a[76:79], v[60:63]
    ds_read_b128 a[108:111], v7 offset:10240
    v_exp_f32 v32, v32
    v_mfma_f32_16x16x32_bf16 v[60:63], a[112:115], a[80:83], v[60:63]
    ds_read_b128 a[112:115], v6 offset:12288
    v_exp_f32 v33, v33
    v_exp_f32 v34, v34
    v_mfma_f32_16x16x32_bf16 v[60:63], a[116:119], a[84:87], v[60:63]
    ds_read_b128 a[116:119], v7 offset:12288
    v_exp_f32 v35, v35
    v_cvt_pk_bf16_f32 v38, v32, v33
    s_add_u32 m0, s31, 1920
    v_mfma_f32_16x16x32_bf16 v[60:63], a[120:123], a[88:91], v[60:63]
    ds_read_b128 a[120:123], v6 offset:14336
    v_add_f32 v26, v32, v33
    buffer_load_dwordx4 v4, s[16:19], s35 offen offset:128  lds
    v_mfma_f32_16x16x32_bf16 v[60:63], a[124:127], a[92:95], v[60:63]
    ds_read_b128 a[124:127], v7 offset:14336
    v_cvt_pk_bf16_f32 v39, v34, v35
    s_add_u32 s38, s38, 1
    s_branch L_loopA_5
L_epA_5:
    s_nop 7
    v_add_f32 v34, v34, v35
    v_add_f32 v26, v26, v34
    ds_read_b32 v11, v9 offset:0
    v_fma_f32 v28, v60, s32, -v17
    v_fma_f32 v29, v61, s32, -v17
    v_fma_f32 v30, v62, s32, -v17
    v_fma_f32 v31, v63, s32, -v17
    v_exp_f32 v28, v28
    v_exp_f32 v29, v29
    v_exp_f32 v30, v30
    v_exp_f32 v31, v31
    v_cvt_pk_bf16_f32 v34, v28, v29
    v_add_f32 v27, v28, v29
    v_cvt_pk_bf16_f32 v35, v30, v31
    v_add_f32 v30, v30, v31
    v_add_f32 v27, v27, v30
    s_waitcnt lgkmcnt(0)
    v_cmp_ne_u32 vcc, s39, v11
    s_cbranch_vccnz L_slowca5
L_retca5:
    v_max3_f32 v32, v23, v24, v25
    v_max3_f32 v32, v32, v26, v27
    s_add_u32 s39, s39, 1
    v_cmp_lt_f32 vcc, s33, v32
    v_mov_b32 v12, s39
    s_cbranch_vccnz L_slowp5
L_retp5:
    ds_write2st64_b64 v8, v[0:1], v[2:3] offset0:20 offset1:24
    ds_write2st64_b64 v8, v[36:37], v[38:39] offset0:28 offset1:32
    ds_write_b64 v8, v[34:35] offset:18432
    ds_write_b32 v10, v12 offset:32
    ds_read_b32 v11, v9 offset:32
    v_add_f32 v18, v18, v23
    v_add_f32 v19, v19, v24
    v_add_f32 v20, v20, v25
    v_add_f32 v21, v21, v26
    v_add_f32 v22, v22, v27
    s_waitcnt lgkmcnt(0)
    v_cmp_ne_u32 vcc, s39, v11
    s_cbranch_vccnz L_slowca6
L_retca6:
    v_mbcnt_lo_u32_b32 v11, -1, 0
    v_mbcnt_hi_u32_b32 v11, -1, v11
    v_and_b32 v11, 15, v11
    v_lshlrev_b32 v11, 4, v11
    v_add_u32 v11, 151552, v11
    s_lshl_b32 s40, s30, 2
    v_add_u32 v11, s40, v11
    v_mov_b32 v28, v18
    s_nop 1
    v_permlane16_swap_b32 v18, v28
    s_nop 0
    v_add_f32 v18, v18, v28
    v_mov_b32 v28, v18
    s_nop 1
    v_permlane32_swap_b32 v18, v28
    s_nop 0
    v_add_f32 v18, v18, v28
    ds_write_b32 v11, v18 offset:2816
    v_mov_b32 v29, v19
    s_nop 1
    v_permlane16_swap_b32 v19, v29
    s_nop 0
    v_add_f32 v19, v19, v29
    v_mov_b32 v29, v19
    s_nop 1
    v_permlane32_swap_b32 v19, v29
    s_nop 0
    v_add_f32 v19, v19, v29
    ds_write_b32 v11, v19 offset:3072
    v_mov_b32 v30, v20
    s_nop 1
    v_permlane16_swap_b32 v20, v30
    s_nop 0
    v_add_f32 v20, v20, v30
    v_mov_b32 v30, v20
    s_nop 1
    v_permlane32_swap_b32 v20, v30
    s_nop 0
    v_add_f32 v20, v20, v30
    ds_write_b32 v11, v20 offset:3328
    v_mov_b32 v31, v21
    s_nop 1
    v_permlane16_swap_b32 v21, v31
    s_nop 0
    v_add_f32 v21, v21, v31
    v_mov_b32 v31, v21
    s_nop 1
    v_permlane32_swap_b32 v21, v31
    s_nop 0
    v_add_f32 v21, v21, v31
    ds_write_b32 v11, v21 offset:3584
    v_mov_b32 v28, v22
    s_nop 1
    v_permlane16_swap_b32 v22, v28
    s_nop 0
    v_add_f32 v22, v22, v28
    v_mov_b32 v28, v22
    s_nop 1
    v_permlane32_swap_b32 v22, v28
    s_nop 0
    v_add_f32 v22, v22, v28
    ds_write_b32 v11, v22 offset:3840
    s_waitcnt lgkmcnt(0)
    s_barrier
    s_branch L_end
L_roleA4:
    ds_read_b128 v[64:67], v13 offset:0
    ds_read_b128 v[68:71], v14 offset:0
    ds_read_b128 v[72:75], v13 offset:2048
    ds_read_b128 v[76:79], v14 offset:2048
    ds_read_b128 v[80:83], v13 offset:4096
    ds_read_b128 v[84:87], v14 offset:4096
    ds_read_b128 v[88:91], v13 offset:6144
    ds_read_b128 v[92:95], v14 offset:6144
    ds_read_b128 v[96:99], v15 offset:0
    ds_read_b128 v[100:103], v16 offset:0
    ds_read_b128 v[104:107], v15 offset:2048
    ds_read_b128 v[108:111], v16 offset:2048
    ds_read_b128 v[112:115], v15 offset:4096
    ds_read_b128 v[116:119], v16 offset:4096
    ds_read_b128 v[120:123], v15 offset:6144
    ds_read_b128 v[124:127], v16 offset:6144
    s_waitcnt vmcnt(0)
    ds_read_b128 a[96:99], v6 offset:0
    ds_read_b128 a[100:103], v7 offset:0
    ds_read_b128 a[104:107], v6 offset:2048
    ds_read_b128 a[108:111], v7 offset:2048
    ds_read_b128 a[112:115], v6 offset:4096
    ds_read_b128 a[116:119], v7 offset:4096
    ds_read_b128 a[120:123], v6 offset:6144
    ds_read_b128 a[124:127], v7 offset:6144
    s_waitcnt lgkmcnt(7)
    v_mfma_f32_16x16x32_bf16 v[40:43], a[96:99], v[64:67], 0
    ds_read_b128 a[0:3], v17 offset:0
    ds_read_b128 a[4:7], v23 offset:0
    ds_read_b128 a[8:11], v17 offset:2048
    s_waitcnt lgkmcnt(9)
    v_mfma_f32_16x16x32_bf16 v[40:43], a[100:103], v[68:71], v[40:43]
    ds_read_b128 a[12:15], v23 offset:2048
    ds_read_b128 a[16:19], v17 offset:4096
    s_waitcnt lgkmcnt(10)
    v_mfma_f32_16x16x32_bf16 v[40:43], a[104:107], v[72:75], v[40:43]
    ds_read_b128 a[20:23], v23 offset:4096
    ds_read_b128 a[24:27], v17 offset:6144
    s_waitcnt lgkmcnt(11)
    v_mfma_f32_16x16x32_bf16 v[40:43], a[108:111], v[76:79], v[40:43]
    ds_read_b128 a[28:31], v23 offset:6144
    ds_read_b128 a[32:35], v24 offset:0
    ds_read_b128 a[36:39], v25 offset:0
    s_waitcnt lgkmcnt(13)
    v_mfma_f32_16x16x32_bf16 v[40:43], a[112:115], v[80:83], v[40:43]
    ds_read_b128 a[40:43], v24 offset:2048
    ds_read_b128 a[44:47], v25 offset:2048
    s_waitcnt lgkmcnt(14)
    v_mfma_f32_16x16x32_bf16 v[40:43], a[116:119], v[84:87], v[40:43]
    ds_read_b128 a[48:51], v24 offset:4096
    ds_read_b128 a[52:55], v25 offset:4096
    s_waitcnt lgkmcnt(15)
    v_mfma_f32_16x16x32_bf16 v[40:43], a[120:123], v[88:91], v[40:43]
    ds_read_b128 a[56:59], v24 offset:6144
    ds_read_b128 a[60:63], v25 offset:6144
    s_waitcnt lgkmcnt(15)
    v_mfma_f32_16x16x32_bf16 v[40:43], a[124:127], v[92:95], v[40:43]
    ds_write_b32 v10, v12 offset:64
    v_mfma_f32_16x16x32_bf16 v[48:51], a[96:99], v[96:99], 0
    v_mfma_f32_16x16x32_bf16 v[48:51], a[100:103], v[100:103], v[48:51]
    v_mfma_f32_16x16x32_bf16 v[48:51], a[104:107], v[104:107], v[48:51]
    s_nop 3
    v_max3_f32 v28, v40, v41, v42
    v_max_f32 v28, v28, v43
    v_mfma_f32_16x16x32_bf16 v[48:51], a[108:111], v[108:111], v[48:51]
    v_mov_b32 v29, v28
    s_nop 1
    v_permlane16_swap_b32 v28, v29
    v_mfma_f32_16x16x32_bf16 v[48:51], a[112:115], v[112:115], v[48:51]
    s_nop 0
    v_max_f32 v28, v28, v29
    v_mfma_f32_16x16x32_bf16 v[48:51], a[116:119], v[116:119], v[48:51]
    v_mov_b32 v29, v28
    v_mfma_f32_16x16x32_bf16 v[48:51], a[120:123], v[120:123], v[48:51]
    s_nop 0
    v_permlane32_swap_b32 v28, v29
    s_nop 0
    v_mfma_f32_16x16x32_bf16 v[48:51], a[124:127], v[124:127], v[48:51]
    v_max_f32 v28, v28, v29
    v_mul_f32 v28, s32, v28
    v_mfma_f32_16x16x32_bf16 v[52:55], a[96:99], a[0:3], 0
    v_ceil_f32 v28, v28
    s_waitcnt lgkmcnt(15)
    v_mfma_f32_16x16x32_bf16 v[52:55], a[100:103], a[4:7], v[52:55]
    ds_write_b32 v11, v28 offset:2816
    s_waitcnt lgkmcnt(15)
    v_mfma_f32_16x16x32_bf16 v[52:55], a[104:107], a[8:11], v[52:55]
    v_max3_f32 v32, v48, v49, v50
    v_max_f32 v32, v32, v51
    s_waitcnt lgkmcnt(14)
    v_mfma_f32_16x16x32_bf16 v[52:55], a[108:111], a[12:15], v[52:55]
    v_mov_b32 v33, v32
    s_nop 1
    v_permlane16_swap_b32 v32, v33
    s_waitcnt lgkmcnt(13)
    v_mfma_f32_16x16x32_bf16 v[52:55], a[112:115], a[16:19], v[52:55]
    s_nop 0
    v_max_f32 v32, v32, v33
    s_waitcnt lgkmcnt(12)
    v_mfma_f32_16x16x32_bf16 v[52:55], a[116:119], a[20:23], v[52:55]
    v_mov_b32 v33, v32
    s_waitcnt lgkmcnt(11)
    v_mfma_f32_16x16x32_bf16 v[52:55], a[120:123], a[24:27], v[52:55]
    v_permlane32_swap_b32 v32, v33
    s_nop 0
    s_waitcnt lgkmcnt(10)
    v_mfma_f32_16x16x32_bf16 v[52:55], a[124:127], a[28:31], v[52:55]
    v_max_f32 v32, v32, v33
    v_mul_f32 v32, s32, v32
    s_waitcnt lgkmcnt(9)
    v_mfma_f32_16x16x32_bf16 v[56:59], a[96:99], a[32:35], 0
    v_ceil_f32 v32, v32
    s_waitcnt lgkmcnt(8)
    v_mfma_f32_16x16x32_bf16 v[56:59], a[100:103], a[36:39], v[56:59]
    ds_write_b32 v11, v32 offset:3072
    s_waitcnt lgkmcnt(8)
    v_mfma_f32_16x16x32_bf16 v[56:59], a[104:107], a[40:43], v[56:59]
    v_max3_f32 v28, v52, v53, v54
    v_max_f32 v28, v28, v55
    v_mov_b32 v29, v28
    s_waitcnt lgkmcnt(7)
    v_mfma_f32_16x16x32_bf16 v[56:59], a[108:111], a[44:47], v[56:59]
    v_permlane16_swap_b32 v28, v29
    s_nop 0
    s_waitcnt lgkmcnt(6)
    v_mfma_f32_16x16x32_bf16 v[56:59], a[112:115], a[48:51], v[56:59]
    v_max_f32 v28, v28, v29
    v_mov_b32 v29, v28
    s_nop 1
    v_permlane32_swap_b32 v28, v29
    s_waitcnt lgkmcnt(5)
    v_mfma_f32_16x16x32_bf16 v[56:59], a[116:119], a[52:55], v[56:59]
    s_nop 0
    v_max_f32 v28, v28, v29
    s_waitcnt lgkmcnt(4)
    v_mfma_f32_16x16x32_bf16 v[56:59], a[120:123], a[56:59], v[56:59]
    v_mul_f32 v28, s32, v28
    v_ceil_f32 v28, v28
    s_waitcnt lgkmcnt(3)
    v_mfma_f32_16x16x32_bf16 v[56:59], a[124:127], a[60:63], v[56:59]
    ds_write_b32 v11, v28 offset:3328
    s_nop 6
    v_max3_f32 v32, v56, v57, v58
    v_max_f32 v32, v32, v59
    v_mov_b32 v33, v32
    s_nop 1
    v_permlane16_swap_b32 v32, v33
    s_nop 0
    v_max_f32 v32, v32, v33
    v_mov_b32 v33, v32
    s_nop 1
    v_permlane32_swap_b32 v32, v33
    s_nop 0
    v_max_f32 v32, v32, v33
    v_mul_f32 v32, s32, v32
    v_ceil_f32 v32, v32
    ds_write_b32 v11, v32 offset:3584
    ds_write_b32 v10, v12 offset:80
    s_lshl_b32 s40, s30, 2
    v_subrev_u32 v11, s40, v11
L_mpoll_4:
    ds_read_b32 v36, v9 offset:64
    s_waitcnt lgkmcnt(0)
    v_cmp_ne_u32 vcc, 1, v36
    s_cbranch_vccnz L_mpoll_4
    ds_read_b128 v[28:31], v11 offset:2816
    ds_read_b128 v[32:35], v11 offset:3072
    ds_read_b128 v[36:39], v11 offset:3328
    ds_read_b128 v[44:47], v11 offset:3584
    s_waitcnt lgkmcnt(3)
    v_max3_f32 v28, v28, v29, v30
    v_max_f32 v13, v28, v31
    s_waitcnt lgkmcnt(2)
    v_max3_f32 v32, v32, v33, v34
    v_max_f32 v14, v32, v35
    s_waitcnt lgkmcnt(1)
    v_max3_f32 v36, v36, v37, v38
    v_max_f32 v15, v36, v39
    s_waitcnt lgkmcnt(0)
    v_max3_f32 v44, v44, v45, v46
    v_max_f32 v16, v44, v47
    v_mov_b32 v18, 0
    v_mov_b32 v19, 0
    v_mov_b32 v20, 0
    v_mov_b32 v21, 0
    ds_read_b32 v11, v10 offset:96
    v_fma_f32 v28, v40, s32, -v13
    v_fma_f32 v29, v41, s32, -v13
    v_fma_f32 v30, v42, s32, -v13
    v_fma_f32 v31, v43, s32, -v13
    v_exp_f32 v28, v28
    v_exp_f32 v29, v29
    v_exp_f32 v30, v30
    v_exp_f32 v31, v31
    v_cvt_pk_bf16_f32 v0, v28, v29
    v_add_f32 v23, v28, v29
    v_cvt_pk_bf16_f32 v1, v30, v31
    v_add_f32 v30, v30, v31
    v_add_f32 v23, v23, v30
    v_fma_f32 v32, v48, s32, -v14
    v_fma_f32 v33, v49, s32, -v14
    v_fma_f32 v34, v50, s32, -v14
    v_fma_f32 v35, v51, s32, -v14
    v_exp_f32 v32, v32
    v_exp_f32 v33, v33
    v_exp_f32 v34, v34
    v_exp_f32 v35, v35
    v_cvt_pk_bf16_f32 v2, v32, v33
    v_add_f32 v24, v32, v33
    v_cvt_pk_bf16_f32 v3, v34, v35
    v_add_f32 v34, v34, v35
    v_add_f32 v24, v24, v34
L_k1poll_4:
    s_waitcnt lgkmcnt(0)
    v_cmp_ne_u32 vcc, 1, v11
    s_cbranch_vccz L_k1ok_4
    ds_read_b32 v11, v10 offset:96
    s_waitcnt lgkmcnt(0)
    s_branch L_k1poll_4
L_k1ok_4:
    ds_read_b128 a[96:99], v6 offset:8192
    ds_read_b128 a[100:103], v7 offset:8192
    ds_read_b128 a[104:107], v6 offset:10240
    ds_read_b128 a[108:111], v7 offset:10240
    ds_read_b128 a[112:115], v6 offset:12288
    ds_read_b128 a[116:119], v7 offset:12288
    ds_read_b128 a[120:123], v6 offset:14336
    ds_read_b128 a[124:127], v7 offset:14336
    v_fma_f32 v28, v52, s32, -v15
    v_fma_f32 v29, v53, s32, -v15
    v_fma_f32 v30, v54, s32, -v15
    v_fma_f32 v31, v55, s32, -v15
    v_exp_f32 v28, v28
    v_exp_f32 v29, v29
    v_exp_f32 v30, v30
    v_exp_f32 v31, v31
    v_cvt_pk_bf16_f32 v36, v28, v29
    v_add_f32 v25, v28, v29
    v_cvt_pk_bf16_f32 v37, v30, v31
    s_mov_b32 m0, s34
    s_add_u32 s34, s34, 1
    s_movrels_b32 s35, s64
    s_add_u32 m0, s31, 0
    s_nop 0
    buffer_load_dwordx4 v4, s[16:19], s35 offen offset:0  lds
    buffer_load_dwordx4 v5, s[16:19], s35 offen offset:1024  lds
    s_add_u32 m0, s31, 1920
    s_nop 0
    buffer_load_dwordx4 v4, s[16:19], s35 offen offset:128  lds
    s_waitcnt lgkmcnt(0)
    s_nop 7
    s_mov_b32 s38, 0
.p2align 3
L_loopA_4:
    s_waitcnt lgkmcnt(7)
    v_mfma_f32_16x16x32_bf16 v[44:47], a[96:99], v[64:67], 0
    v_add_f32 v30, v30, v31
    v_add_f32 v25, v25, v30
    s_waitcnt lgkmcnt(6)
    v_mfma_f32_16x16x32_bf16 v[44:47], a[100:103], v[68:71], v[44:47]
    ds_read_b32 v11, v9 offset:32
    v_fma_f32 v32, v56, s32, -v16
    v_fma_f32 v33, v57, s32, -v16
    buffer_load_dwordx4 v5, s[16:19], s35 offen offset:1152  lds
    s_waitcnt lgkmcnt(6)
    v_mfma_f32_16x16x32_bf16 v[44:47], a[104:107], v[72:75], v[44:47]
    v_fma_f32 v34, v58, s32, -v16
    v_fma_f32 v35, v59, s32, -v16
    s_waitcnt lgkmcnt(5)
    v_mfma_f32_16x16x32_bf16 v[44:47], a[108:111], v[76:79], v[44:47]
    v_exp_f32 v32, v32
    v_exp_f32 v33, v33
    s_add_u32 m0, s31, 3840
    s_waitcnt lgkmcnt(4)
    v_mfma_f32_16x16x32_bf16 v[44:47], a[112:115], v[80:83], v[44:47]
    v_exp_f32 v34, v34
    v_exp_f32 v35, v35
    v_cvt_pk_bf16_f32 v38, v32, v33
    buffer_load_dwordx4 v4, s[16:19], s35 offen offset:256  lds
    s_waitcnt lgkmcnt(3)
    v_mfma_f32_16x16x32_bf16 v[44:47], a[116:119], v[84:87], v[44:47]
    v_add_f32 v26, v32, v33
    v_cvt_pk_bf16_f32 v39, v34, v35
    s_waitcnt lgkmcnt(2)
    v_mfma_f32_16x16x32_bf16 v[44:47], a[120:123], v[88:91], v[44:47]
    v_add_f32 v34, v34, v35
    v_add_f32 v26, v26, v34
    s_waitcnt lgkmcnt(1)
    v_mfma_f32_16x16x32_bf16 v[44:47], a[124:127], v[92:95], v[44:47]
    s_waitcnt lgkmcnt(0)
    v_cmp_ne_u32 vcc, s39, v11
    s_cbranch_vccnz L_slowca9
L_retca9:
    v_max3_f32 v32, v23, v24, v25
    v_max_f32 v32, v32, v26
    s_add_u32 s39, s39, 1
    v_cmp_lt_f32 vcc, s33, v32
    v_mov_b32 v12, s39
    s_cbranch_vccnz L_slowp9
L_retp9:
    ds_write2st64_b64 v8, v[0:1], v[2:3] offset0:0 offset1:4
    ds_write2st64_b64 v8, v[36:37], v[38:39] offset0:8 offset1:12
    ds_write_b32 v10, v12 offset:0
    buffer_load_dwordx4 v5, s[16:19], s35 offen offset:1280  lds
    v_mfma_f32_16x16x32_bf16 v[48:51], a[96:99], v[96:99], 0
    v_add_f32 v18, v18, v23
    v_add_f32 v19, v19, v24
    v_mfma_f32_16x16x32_bf16 v[48:51], a[100:103], v[100:103], v[48:51]
    v_add_f32 v20, v20, v25
    s_add_u32 m0, s31, 5760
    v_mfma_f32_16x16x32_bf16 v[48:51], a[104:107], v[104:107], v[48:51]
    v_add_f32 v21, v21, v26
    v_fma_f32 v28, v44, s32, -v13
    v_fma_f32 v29, v45, s32, -v13
    buffer_load_dwordx4 v4, s[16:19], s35 offen offset:384  lds
    v_mfma_f32_16x16x32_bf16 v[48:51], a[108:111], v[108:111], v[48:51]
    v_fma_f32 v30, v46, s32, -v13
    v_fma_f32 v31, v47, s32, -v13
    v_mfma_f32_16x16x32_bf16 v[48:51], a[112:115], v[112:115], v[48:51]
    v_exp_f32 v28, v28
    v_exp_f32 v29, v29
    v_mfma_f32_16x16x32_bf16 v[48:51], a[116:119], v[116:119], v[48:51]
    v_exp_f32 v30, v30
    v_exp_f32 v31, v31
    buffer_load_dwordx4 v5, s[16:19], s35 offen offset:1408  lds
    v_mfma_f32_16x16x32_bf16 v[48:51], a[120:123], v[120:123], v[48:51]
    v_cvt_pk_bf16_f32 v0, v28, v29
    v_add_f32 v23, v28, v29
    v_mfma_f32_16x16x32_bf16 v[48:51], a[124:127], v[124:127], v[48:51]
    v_cvt_pk_bf16_f32 v1, v30, v31
    v_add_f32 v30, v30, v31
    v_mfma_f32_16x16x32_bf16 v[52:55], a[96:99], a[0:3], 0
    v_add_f32 v23, v23, v30
    v_mfma_f32_16x16x32_bf16 v[52:55], a[100:103], a[4:7], v[52:55]
    s_nop 2
    v_fma_f32 v32, v48, s32, -v14
    v_fma_f32 v33, v49, s32, -v14
    v_mfma_f32_16x16x32_bf16 v[52:55], a[104:107], a[8:11], v[52:55]
    v_fma_f32 v34, v50, s32, -v14
    v_fma_f32 v35, v51, s32, -v14
    v_mfma_f32_16x16x32_bf16 v[52:55], a[108:111], a[12:15], v[52:55]
    v_exp_f32 v32, v32
    v_exp_f32 v33, v33
    v_mfma_f32_16x16x32_bf16 v[52:55], a[112:115], a[16:19], v[52:55]
    v_exp_f32 v34, v34
    s_mov_b32 m0, s34
    v_mfma_f32_16x16x32_bf16 v[52:55], a[116:119], a[20:23], v[52:55]
    v_exp_f32 v35, v35
    v_cvt_pk_bf16_f32 v2, v32, v33
    s_add_u32 s34, s34, 1
    v_mfma_f32_16x16x32_bf16 v[52:55], a[120:123], a[24:27], v[52:55]
    v_add_f32 v24, v32, v33
    v_cvt_pk_bf16_f32 v3, v34, v35
    s_movrels_b32 s35, s64
    v_mfma_f32_16x16x32_bf16 v[52:55], a[124:127], a[28:31], v[52:55]
    v_add_f32 v34, v34, v35
    s_add_u32 m0, s31, 8192
    v_mfma_f32_16x16x32_bf16 v[56:59], a[96:99], a[32:35], 0
    s_waitcnt vmcnt(0)
    ds_read_b128 a[96:99], v6 offset:0
    v_add_f32 v24, v24, v34
    buffer_load_dwordx4 v4, s[16:19], s35 offen offset:0  lds
    v_mfma_f32_16x16x32_bf16 v[56:59], a[100:103], a[36:39], v[56:59]
    ds_read_b128 a[100:103], v7 offset:0
    v_fma_f32 v28, v52, s32, -v15
    v_fma_f32 v29, v53, s32, -v15
    v_mfma_f32_16x16x32_bf16 v[56:59], a[104:107], a[40:43], v[56:59]
    ds_read_b128 a[104:107], v6 offset:2048
    v_fma_f32 v30, v54, s32, -v15
    v_fma_f32 v31, v55, s32, -v15
    v_mfma_f32_16x16x32_bf16 v[56:59], a[108:111], a[44:47], v[56:59]
    ds_read_b128 a[108:111], v7 offset:2048
    v_exp_f32 v28, v28
    buffer_load_dwordx4 v5, s[16:19], s35 offen offset:1024  lds
    v_mfma_f32_16x16x32_bf16 v[56:59], a[112:115], a[48:51], v[56:59]
    ds_read_b128 a[112:115], v6 offset:4096
    v_exp_f32 v29, v29
    v_exp_f32 v30, v30
    v_mfma_f32_16x16x32_bf16 v[56:59], a[116:119], a[52:55], v[56:59]
    ds_read_b128 a[116:119], v7 offset:4096
    v_exp_f32 v31, v31
    v_cvt_pk_bf16_f32 v36, v28, v29
    s_add_u32 m0, s31, 10112
    v_mfma_f32_16x16x32_bf16 v[56:59], a[120:123], a[56:59], v[56:59]
    ds_read_b128 a[120:123], v6 offset:6144
    v_add_f32 v25, v28, v29
    buffer_load_dwordx4 v4, s[16:19], s35 offen offset:128  lds
    v_mfma_f32_16x16x32_bf16 v[56:59], a[124:127], a[60:63], v[56:59]
    ds_read_b128 a[124:127], v7 offset:6144
    v_cvt_pk_bf16_f32 v37, v30, v31
    s_cmp_eq_u32 s38, 7
    s_cbranch_scc1 L_epA_4
    s_waitcnt lgkmcnt(7)
    v_mfma_f32_16x16x32_bf16 v[40:43], a[96:99], v[64:67], 0
    v_add_f32 v30, v30, v31
    v_add_f32 v25, v25, v30
    s_waitcnt lgkmcnt(6)
    v_mfma_f32_16x16x32_bf16 v[40:43], a[100:103], v[68:71], v[40:43]
    ds_read_b32 v11, v9 offset:0
    v_fma_f32 v32, v56, s32, -v16
    v_fma_f32 v33, v57, s32, -v16
    buffer_load_dwordx4 v5, s[16:19], s35 offen offset:1152  lds
    s_waitcnt lgkmcnt(6)
    v_mfma_f32_16x16x32_bf16 v[40:43], a[104:107], v[72:75], v[40:43]
    v_fma_f32 v34, v58, s32, -v16
    v_fma_f32 v35, v59, s32, -v16
    s_waitcnt lgkmcnt(5)
    v_mfma_f32_16x16x32_bf16 v[40:43], a[108:111], v[76:79], v[40:43]
    v_exp_f32 v32, v32
    v_exp_f32 v33, v33
    s_add_u32 m0, s31, 12032
    s_waitcnt lgkmcnt(4)
    v_mfma_f32_16x16x32_bf16 v[40:43], a[112:115], v[80:83], v[40:43]
    v_exp_f32 v34, v34
    v_exp_f32 v35, v35
    v_cvt_pk_bf16_f32 v38, v32, v33
    buffer_load_dwordx4 v4, s[16:19], s35 offen offset:256  lds
    s_waitcnt lgkmcnt(3)
    v_mfma_f32_16x16x32_bf16 v[40:43], a[116:119], v[84:87], v[40:43]
    v_add_f32 v26, v32, v33
    v_cvt_pk_bf16_f32 v39, v34, v35
    s_waitcnt lgkmcnt(2)
    v_mfma_f32_16x16x32_bf16 v[40:43], a[120:123], v[88:91], v[40:43]
    v_add_f32 v34, v34, v35
    v_add_f32 v26, v26, v34
    s_waitcnt lgkmcnt(1)
    v_mfma_f32_16x16x32_bf16 v[40:43], a[124:127], v[92:95], v[40:43]
    s_waitcnt lgkmcnt(0)
    v_cmp_ne_u32 vcc, s39, v11
    s_cbranch_vccnz L_slowca10
L_retca10:
    v_max3_f32 v32, v23, v24, v25
    v_max_f32 v32, v32, v26
    s_add_u32 s39, s39, 1
    v_cmp_lt_f32 vcc, s33, v32
    v_mov_b32 v12, s39
    s_cbranch_vccnz L_slowp10
L_retp10:
    ds_write2st64_b64 v8, v[0:1], v[2:3] offset0:20 offset1:24
    ds_write2st64_b64 v8, v[36:37], v[38:39] offset0:28 offset1:32
    ds_write_b32 v10, v12 offset:32
    buffer_load_dwordx4 v5, s[16:19], s35 offen offset:1280  lds
    v_mfma_f32_16x16x32_bf16 v[48:51], a[96:99], v[96:99], 0
    v_add_f32 v18, v18, v23
    v_add_f32 v19, v19, v24
    v_mfma_f32_16x16x32_bf16 v[48:51], a[100:103], v[100:103], v[48:51]
    v_add_f32 v20, v20, v25
    s_add_u32 m0, s31, 13952
    v_mfma_f32_16x16x32_bf16 v[48:51], a[104:107], v[104:107], v[48:51]
    v_add_f32 v21, v21, v26
    v_fma_f32 v28, v40, s32, -v13
    v_fma_f32 v29, v41, s32, -v13
    buffer_load_dwordx4 v4, s[16:19], s35 offen offset:384  lds
    v_mfma_f32_16x16x32_bf16 v[48:51], a[108:111], v[108:111], v[48:51]
    v_fma_f32 v30, v42, s32, -v13
    v_fma_f32 v31, v43, s32, -v13
    v_mfma_f32_16x16x32_bf16 v[48:51], a[112:115], v[112:115], v[48:51]
    v_exp_f32 v28, v28
    v_exp_f32 v29, v29
    v_mfma_f32_16x16x32_bf16 v[48:51], a[116:119], v[116:119], v[48:51]
    v_exp_f32 v30, v30
    v_exp_f32 v31, v31
    buffer_load_dwordx4 v5, s[16:19], s35 offen offset:1408  lds
    v_mfma_f32_16x16x32_bf16 v[48:51], a[120:123], v[120:123], v[48:51]
    v_cvt_pk_bf16_f32 v0, v28, v29
    v_add_f32 v23, v28, v29
    v_mfma_f32_16x16x32_bf16 v[48:51], a[124:127], v[124:127], v[48:51]
    v_cvt_pk_bf16_f32 v1, v30, v31
    v_add_f32 v30, v30, v31
    v_mfma_f32_16x16x32_bf16 v[52:55], a[96:99], a[0:3], 0
    v_add_f32 v23, v23, v30
    v_mfma_f32_16x16x32_bf16 v[52:55], a[100:103], a[4:7], v[52:55]
    s_nop 2
    v_fma_f32 v32, v48, s32, -v14
    v_fma_f32 v33, v49, s32, -v14
    v_mfma_f32_16x16x32_bf16 v[52:55], a[104:107], a[8:11], v[52:55]
    v_fma_f32 v34, v50, s32, -v14
    v_fma_f32 v35, v51, s32, -v14
    v_mfma_f32_16x16x32_bf16 v[52:55], a[108:111], a[12:15], v[52:55]
    v_exp_f32 v32, v32
    v_exp_f32 v33, v33
    v_mfma_f32_16x16x32_bf16 v[52:55], a[112:115], a[16:19], v[52:55]
    v_exp_f32 v34, v34
    s_mov_b32 m0, s34
    v_mfma_f32_16x16x32_bf16 v[52:55], a[116:119], a[20:23], v[52:55]
    v_exp_f32 v35, v35
    v_cvt_pk_bf16_f32 v2, v32, v33
    s_add_u32 s34, s34, 1
    v_mfma_f32_16x16x32_bf16 v[52:55], a[120:123], a[24:27], v[52:55]
    v_add_f32 v24, v32, v33
    v_cvt_pk_bf16_f32 v3, v34, v35
    s_movrels_b32 s35, s64
    v_mfma_f32_16x16x32_bf16 v[52:55], a[124:127], a[28:31], v[52:55]
    v_add_f32 v34, v34, v35
    s_add_u32 m0, s31, 0
    v_mfma_f32_16x16x32_bf16 v[56:59], a[96:99], a[32:35], 0
    s_waitcnt vmcnt(0)
    ds_read_b128 a[96:99], v6 offset:8192
    v_add_f32 v24, v24, v34
    buffer_load_dwordx4 v4, s[16:19], s35 offen offset:0  lds
    v_mfma_f32_16x16x32_bf16 v[56:59], a[100:103], a[36:39], v[56:59]
    ds_read_b128 a[100:103], v7 offset:8192
    v_fma_f32 v28, v52, s32, -v15
    v_fma_f32 v29, v53, s32, -v15
    v_mfma_f32_16x16x32_bf16 v[56:59], a[104:107], a[40:43], v[56:59]
    ds_read_b128 a[104:107], v6 offset:10240
    v_fma_f32 v30, v54, s32, -v15
    v_fma_f32 v31, v55, s32, -v15
    v_mfma_f32_16x16x32_bf16 v[56:59], a[108:111], a[44:47], v[56:59]
    ds_read_b128 a[108:111], v7 offset:10240
    v_exp_f32 v28, v28
    buffer_load_dwordx4 v5, s[16:19], s35 offen offset:1024  lds
    v_mfma_f32_16x16x32_bf16 v[56:59], a[112:115], a[48:51], v[56:59]
    ds_read_b128 a[112:115], v6 offset:12288
    v_exp_f32 v29, v29
    v_exp_f32 v30, v30
    v_mfma_f32_16x16x32_bf16 v[56:59], a[116:119], a[52:55], v[56:59]
    ds_read_b128 a[116:119], v7 offset:12288
    v_exp_f32 v31, v31
    v_cvt_pk_bf16_f32 v36, v28, v29
    s_add_u32 m0, s31, 1920
    v_mfma_f32_16x16x32_bf16 v[56:59], a[120:123], a[56:59], v[56:59]
    ds_read_b128 a[120:123], v6 offset:14336
    v_add_f32 v25, v28, v29
    buffer_load_dwordx4 v4, s[16:19], s35 offen offset:128  lds
    v_mfma_f32_16x16x32_bf16 v[56:59], a[124:127], a[60:63], v[56:59]
    ds_read_b128 a[124:127], v7 offset:14336
    v_cvt_pk_bf16_f32 v37, v30, v31
    s_add_u32 s38, s38, 1
    s_branch L_loopA_4
L_epA_4:
    s_nop 7
    v_add_f32 v30, v30, v31
    v_add_f32 v25, v25, v30
    ds_read_b32 v11, v9 offset:0
    v_fma_f32 v32, v56, s32, -v16
    v_fma_f32 v33, v57, s32, -v16
    v_fma_f32 v34, v58, s32, -v16
    v_fma_f32 v35, v59, s32, -v16
    v_exp_f32 v32, v32
    v_exp_f32 v33, v33
    v_exp_f32 v34, v34
    v_exp_f32 v35, v35
    v_cvt_pk_bf16_f32 v38, v32, v33
    v_add_f32 v26, v32, v33
    v_cvt_pk_bf16_f32 v39, v34, v35
    v_add_f32 v34, v34, v35
    v_add_f32 v26, v26, v34
    s_waitcnt lgkmcnt(0)
    v_cmp_ne_u32 vcc, s39, v11
    s_cbranch_vccnz L_slowca11
L_retca11:
    v_max3_f32 v32, v23, v24, v25
    v_max_f32 v32, v32, v26
    s_add_u32 s39, s39, 1
    v_cmp_lt_f32 vcc, s33, v32
    v_mov_b32 v12, s39
    s_cbranch_vccnz L_slowp11
L_retp11:
    ds_write2st64_b64 v8, v[0:1], v[2:3] offset0:20 offset1:24
    ds_write2st64_b64 v8, v[36:37], v[38:39] offset0:28 offset1:32
    ds_write_b32 v10, v12 offset:32
    ds_read_b32 v11, v9 offset:32
    v_add_f32 v18, v18, v23
    v_add_f32 v19, v19, v24
    v_add_f32 v20, v20, v25
    v_add_f32 v21, v21, v26
    s_waitcnt lgkmcnt(0)
    v_cmp_ne_u32 vcc, s39, v11
    s_cbranch_vccnz L_slowca12
L_retca12:
    v_mbcnt_lo_u32_b32 v11, -1, 0
    v_mbcnt_hi_u32_b32 v11, -1, v11
    v_and_b32 v11, 15, v11
    v_lshlrev_b32 v11, 4, v11
    v_add_u32 v11, 151552, v11
    s_lshl_b32 s40, s30, 2
    v_add_u32 v11, s40, v11
    v_mov_b32 v28, v18
    s_nop 1
    v_permlane16_swap_b32 v18, v28
    s_nop 0
    v_add_f32 v18, v18, v28
    v_mov_b32 v28, v18
    s_nop 1
    v_permlane32_swap_b32 v18, v28
    s_nop 0
    v_add_f32 v18, v18, v28
    ds_write_b32 v11, v18 offset:2816
    v_mov_b32 v29, v19
    s_nop 1
    v_permlane16_swap_b32 v19, v29
    s_nop 0
    v_add_f32 v19, v19, v29
    v_mov_b32 v29, v19
    s_nop 1
    v_permlane32_swap_b32 v19, v29
    s_nop 0
    v_add_f32 v19, v19, v29
    ds_write_b32 v11, v19 offset:3072
    v_mov_b32 v30, v20
    s_nop 1
    v_permlane16_swap_b32 v20, v30
    s_nop 0
    v_add_f32 v20, v20, v30
    v_mov_b32 v30, v20
    s_nop 1
    v_permlane32_swap_b32 v20, v30
    s_nop 0
    v_add_f32 v20, v20, v30
    ds_write_b32 v11, v20 offset:3328
    v_mov_b32 v31, v21
    s_nop 1
    v_permlane16_swap_b32 v21, v31
    s_nop 0
    v_add_f32 v21, v21, v31
    v_mov_b32 v31, v21
    s_nop 1
    v_permlane32_swap_b32 v21, v31
    s_nop 0
    v_add_f32 v21, v21, v31
    ds_write_b32 v11, v21 offset:3584
    s_waitcnt lgkmcnt(0)
    s_barrier
    s_branch L_end
L_roleB:
    v_mov_b32 v25, v114
    v_mov_b32 v26, v115
    v_lshrrev_b32 v109, 3, v100
    v_lshlrev_b32 v109, 9, v109
    v_lshlrev_b32 v110, 7, v102
    v_add_u32 v109, v109, v110
    v_lshlrev_b32 v110, 1, v107
    v_and_b32 v111, 7, v100
    v_xor_b32 v110, v110, v111
    v_lshl_add_u32 v109, v110, 4, v109
    v_add_u32 v1, 0, v109
    v_add_u32 v2, 3072, v109
    v_add_u32 v3, 6144, v109
    v_add_u32 v4, 9216, v109
    v_add_u32 v5, 16384, v109
    v_add_u32 v6, 19456, v109
    v_add_u32 v7, 22528, v109
    v_add_u32 v8, 25600, v109
    v_lshlrev_b32 v109, 2, v107
    v_lshrrev_b32 v110, 2, v108
    v_add_u32 v109, v109, v110
    v_lshrrev_b32 v110, 1, v109
    v_and_b32 v110, 3, v110
    v_lshlrev_b32 v109, 7, v109
    v_and_b32 v111, 3, v108
    v_lshl_add_u32 v109, v111, 3, v109
    v_add_u32 v109, s31, v109
    v_xor_b32 v111, 0, v110
    v_lshl_add_u32 v9, v111, 5, v109
    v_xor_b32 v111, 1, v110
    v_lshl_add_u32 v10, v111, 5, v109
    v_xor_b32 v111, 2, v110
    v_lshl_add_u32 v11, v111, 5, v109
    v_xor_b32 v111, 3, v110
    v_lshl_add_u32 v12, v111, 5, v109
    v_lshlrev_b32 v109, 4, v100
    v_add_u32 v13, 131072, v109
    v_and_b32 v109, 3, v100
    v_lshlrev_b32 v109, 2, v109
    v_add_u32 v14, 154112, v109
    v_lshlrev_b32 v110, 2, v102
    v_add_u32 v15, 154112, v110
    v_mbcnt_lo_u32_b32 v19, -1, 0
    v_mbcnt_hi_u32_b32 v19, -1, v19
    v_and_b32 v19, 15, v19
    v_lshlrev_b32 v19, 4, v19
    v_add_u32 v19, 151552, v19
    v_lshlrev_b32 v109, 9, v108
    v_lshl_add_u32 v109, v102, 7, v109
    v_and_b32 v110, 1, v107
    v_lshl_add_u32 v109, v110, 5, v109
    v_lshrrev_b32 v110, 1, v107
    v_lshl_add_u32 v18, v110, 4, v109
    v_mov_b32 v48, 0
    v_mov_b32 v49, 0
    v_mov_b32 v50, 0
    v_mov_b32 v51, 0
    v_mov_b32 v52, 0
    v_mov_b32 v53, 0
    v_mov_b32 v54, 0
    v_mov_b32 v55, 0
    v_mov_b32 v56, 0
    v_mov_b32 v57, 0
    v_mov_b32 v58, 0
    v_mov_b32 v59, 0
    v_mov_b32 v60, 0
    v_mov_b32 v61, 0
    v_mov_b32 v62, 0
    v_mov_b32 v63, 0
    v_mov_b32 v64, 0
    v_mov_b32 v65, 0
    v_mov_b32 v66, 0
    v_mov_b32 v67, 0
    v_mov_b32 v68, 0
    v_mov_b32 v69, 0
    v_mov_b32 v70, 0
    v_mov_b32 v71, 0
    v_mov_b32 v72, 0
    v_mov_b32 v73, 0
    v_mov_b32 v74, 0
    v_mov_b32 v75, 0
    v_mov_b32 v76, 0
    v_mov_b32 v77, 0
    v_mov_b32 v78, 0
    v_mov_b32 v79, 0
    v_mov_b32 v80, 0
    v_mov_b32 v81, 0
    v_mov_b32 v82, 0
    v_mov_b32 v83, 0
    v_mov_b32 v84, 0
    v_mov_b32 v85, 0
    v_mov_b32 v86, 0
    v_mov_b32 v87, 0
    v_mov_b32 v88, 0
    v_mov_b32 v89, 0
    v_mov_b32 v90, 0
    v_mov_b32 v91, 0
    v_mov_b32 v92, 0
    v_mov_b32 v93, 0
    v_mov_b32 v94, 0
    v_mov_b32 v95, 0
    v_mov_b32 v96, 0
    v_mov_b32 v97, 0
    v_mov_b32 v98, 0
    v_mov_b32 v99, 0
    v_mov_b32 v100, 0
    v_mov_b32 v101, 0
    v_mov_b32 v102, 0
    v_mov_b32 v103, 0
    v_mov_b32 v104, 0
    v_mov_b32 v105, 0
    v_mov_b32 v106, 0
    v_mov_b32 v107, 0
    v_mov_b32 v108, 0
    v_mov_b32 v109, 0
    v_mov_b32 v110, 0
    v_mov_b32 v111, 0
    v_mov_b32 v112, 0
    v_mov_b32 v113, 0
    v_mov_b32 v114, 0
    v_mov_b32 v115, 0
    v_mov_b32 v116, 0
    v_mov_b32 v117, 0
    v_mov_b32 v118, 0
    v_mov_b32 v119, 0
    v_mov_b32 v120, 0
    v_mov_b32 v121, 0
    v_mov_b32 v122, 0
    v_mov_b32 v123, 0
    v_mov_b32 v124, 0
    v_mov_b32 v125, 0
    v_mov_b32 v126, 0
    v_mov_b32 v127, 0
    s_mov_b32 s51, 8192
    s_mov_b32 s52, 16384
    s_mov_b32 s53, 24576
    s_mov_b32 s54, 32768
    s_mov_b32 s39, 1
    s_mov_b32 s35, s64
    s_mov_b32 s34, 3
    s_waitcnt vmcnt(0)
    s_barrier
    s_add_u32 m0, s31, 8192
    s_nop 0
    buffer_load_dwordx4 v25, s[16:19], s65 offen offset:0  lds
    buffer_load_dwordx4 v26, s[16:19], s65 offen offset:1024  lds
    s_add_u32 m0, s31, 10112
    s_nop 0
    buffer_load_dwordx4 v25, s[16:19], s65 offen offset:128  lds
    buffer_load_dwordx4 v26, s[16:19], s65 offen offset:1152  lds
    s_add_u32 m0, s31, 12032
    s_nop 0
    buffer_load_dwordx4 v25, s[16:19], s65 offen offset:256  lds
    buffer_load_dwordx4 v26, s[16:19], s65 offen offset:1280  lds
    s_add_u32 m0, s31, 13952
    s_nop 0
    buffer_load_dwordx4 v25, s[16:19], s65 offen offset:384  lds
    buffer_load_dwordx4 v26, s[16:19], s65 offen offset:1408  lds
    s_add_u32 m0, s31, 16384
    s_nop 0
    buffer_load_dwordx4 v1, s[20:23], s35 offen offset:0  lds
    buffer_load_dwordx4 v2, s[20:23], s35 offen offset:1024  lds
    buffer_load_dwordx4 v3, s[20:23], s35 offen offset:2048  lds
    buffer_load_dwordx4 v4, s[20:23], s35 offen offset:3072  lds
    s_add_u32 m0, s31, 20480
    s_nop 0
    buffer_load_dwordx4 v5, s[20:23], s35 offen offset:0  lds
    buffer_load_dwordx4 v6, s[20:23], s35 offen offset:1024  lds
    buffer_load_dwordx4 v7, s[20:23], s35 offen offset:2048  lds
    buffer_load_dwordx4 v8, s[20:23], s35 offen offset:3072  lds
    v_mov_b32 v16, 1
    s_waitcnt vmcnt(8)
    ds_write_b32 v15, v16 offset:96
L_qpoll:
    ds_read_b32 v17, v14 offset:64
    s_waitcnt lgkmcnt(0)
    v_cmp_ne_u32 vcc, 1, v17
    s_cbranch_vccnz L_qpoll
    s_mov_b32 s35, s65
    s_add_u32 m0, s31, 24576
    s_nop 0
    buffer_load_dwordx4 v1, s[20:23], s35 offen offset:0  lds
    buffer_load_dwordx4 v2, s[20:23], s35 offen offset:1024  lds
    buffer_load_dwordx4 v3, s[20:23], s35 offen offset:2048  lds
    buffer_load_dwordx4 v4, s[20:23], s35 offen offset:3072  lds
    s_add_u32 m0, s31, 28672
    s_nop 0
    buffer_load_dwordx4 v5, s[20:23], s35 offen offset:0  lds
    buffer_load_dwordx4 v6, s[20:23], s35 offen offset:1024  lds
    buffer_load_dwordx4 v7, s[20:23], s35 offen offset:2048  lds
    buffer_load_dwordx4 v8, s[20:23], s35 offen offset:3072  lds
    s_waitcnt vmcnt(8)
    ds_read_b64_tr_b16 a[0:1], v9 offset:16384
    ds_read_b64_tr_b16 a[2:3], v9 offset:18432
    ds_read_b64_tr_b16 a[4:5], v10 offset:16384
    ds_read_b64_tr_b16 a[6:7], v10 offset:18432
    ds_read_b64_tr_b16 a[8:9], v11 offset:16384
    ds_read_b64_tr_b16 a[10:11], v11 offset:18432
    ds_read_b64_tr_b16 a[12:13], v12 offset:16384
    ds_read_b64_tr_b16 a[14:15], v12 offset:18432
    ds_read_b64_tr_b16 a[16:17], v9 offset:20480
    ds_read_b64_tr_b16 a[18:19], v9 offset:22528
    ds_read_b64_tr_b16 a[20:21], v10 offset:20480
    ds_read_b64_tr_b16 a[22:23], v10 offset:22528
    ds_read_b64_tr_b16 a[24:25], v11 offset:20480
    ds_read_b64_tr_b16 a[26:27], v11 offset:22528
    ds_read_b64_tr_b16 a[28:29], v12 offset:20480
    ds_read_b64_tr_b16 a[30:31], v12 offset:22528
    s_waitcnt lgkmcnt(0)
    s_mov_b32 s35, s66
    s_cmp_ge_u32 s28, 2
    s_cbranch_scc1 L_roleB4
    s_add_u32 m0, s31, 16384
    s_nop 0
    buffer_load_dwordx4 v1, s[20:23], s35 offen offset:0  lds
    buffer_load_dwordx4 v2, s[20:23], s35 offen offset:1024  lds
    buffer_load_dwordx4 v3, s[20:23], s35 offen offset:2048  lds
L_mpollB_5:
    ds_read_b32 v17, v14 offset:80
    s_waitcnt lgkmcnt(0)
    v_cmp_ne_u32 vcc, 1, v17
    s_cbranch_vccnz L_mpollB_5
    ds_read_b128 v[28:31], v19 offset:2816
    ds_read_b128 v[32:35], v19 offset:3072
    ds_read_b128 v[36:39], v19 offset:3328
    ds_read_b128 v[44:47], v19 offset:3584
    s_waitcnt lgkmcnt(3)
    v_max3_f32 v28, v28, v29, v30
    v_max_f32 v20, v28, v31
    s_waitcnt lgkmcnt(2)
    v_max3_f32 v32, v32, v33, v34
    v_max_f32 v21, v32, v35
    s_waitcnt lgkmcnt(1)
    v_max3_f32 v36, v36, v37, v38
    v_max_f32 v22, v36, v39
    s_waitcnt lgkmcnt(0)
    v_max3_f32 v44, v44, v45, v46
    v_max_f32 v23, v44, v47
    ds_read_b128 v[28:31], v19 offset:3840
    ds_read_b32 v17, v14 offset:0
    s_waitcnt lgkmcnt(1)
    v_max3_f32 v28, v28, v29, v30
    v_max_f32 v24, v28, v31
    s_waitcnt lgkmcnt(0)
    v_cmp_ne_u32 vcc, s39, v17
    s_cbranch_vccnz L_slowcb13
L_retcb13:
    ds_read_b128 a[64:67], v13 offset:0
    ds_read_b128 a[68:71], v13 offset:1024
    ds_read_b128 a[72:75], v13 offset:2048
    ds_read_b128 a[76:79], v13 offset:3072
    ds_read_b128 a[80:83], v13 offset:4096
    ds_read_b128 a[84:87], v13 offset:5120
    ds_read_b128 a[88:91], v13 offset:6144
    ds_read_b128 a[92:95], v13 offset:7168
    s_waitcnt lgkmcnt(0)
    s_nop 3
    s_mov_b32 s38, 0
.p2align 3
L_loopB_5:
    v_mfma_f32_16x16x32_bf16 v[48:51], a[0:3], a[64:67], v[48:51]
    ds_read_b128 a[96:99], v13 offset:8192
    ds_read_b128 a[100:103], v13 offset:9216
    buffer_load_dwordx4 v4, s[20:23], s35 offen offset:3072  lds
    v_mfma_f32_16x16x32_bf16 v[52:55], a[4:7], a[64:67], v[52:55]
    s_add_u32 s39, s39, 1
    v_mfma_f32_16x16x32_bf16 v[56:59], a[8:11], a[64:67], v[56:59]
    v_mov_b32 v16, s39
    v_mfma_f32_16x16x32_bf16 v[60:63], a[12:15], a[64:67], v[60:63]
    ds_write_b32 v15, v16 offset:48
    v_mfma_f32_16x16x32_bf16 v[48:51], a[16:19], a[68:71], v[48:51]
    s_add_u32 m0, s31, 20480
    v_mfma_f32_16x16x32_bf16 v[52:55], a[20:23], a[68:71], v[52:55]
    buffer_load_dwordx4 v5, s[20:23], s35 offen offset:0  lds
    v_mfma_f32_16x16x32_bf16 v[56:59], a[24:27], a[68:71], v[56:59]
    v_mfma_f32_16x16x32_bf16 v[60:63], a[28:31], a[68:71], v[60:63]
    v_mfma_f32_16x16x32_bf16 v[64:67], a[0:3], a[72:75], v[64:67]
    v_mfma_f32_16x16x32_bf16 v[68:71], a[4:7], a[72:75], v[68:71]
    v_mfma_f32_16x16x32_bf16 v[72:75], a[8:11], a[72:75], v[72:75]
    buffer_load_dwordx4 v6, s[20:23], s35 offen offset:1024  lds
    v_mfma_f32_16x16x32_bf16 v[76:79], a[12:15], a[72:75], v[76:79]
    v_mfma_f32_16x16x32_bf16 v[64:67], a[16:19], a[76:79], v[64:67]
    v_mfma_f32_16x16x32_bf16 v[68:71], a[20:23], a[76:79], v[68:71]
    v_mfma_f32_16x16x32_bf16 v[72:75], a[24:27], a[76:79], v[72:75]
    v_mfma_f32_16x16x32_bf16 v[76:79], a[28:31], a[76:79], v[76:79]
    buffer_load_dwordx4 v7, s[20:23], s35 offen offset:2048  lds
    v_mfma_f32_16x16x32_bf16 v[80:83], a[0:3], a[80:83], v[80:83]
    v_mfma_f32_16x16x32_bf16 v[84:87], a[4:7], a[80:83], v[84:87]
    v_mfma_f32_16x16x32_bf16 v[88:91], a[8:11], a[80:83], v[88:91]
    s_waitcnt vmcnt(11)
    ds_read_b64_tr_b16 a[32:33], v9 offset:24576
    ds_read_b64_tr_b16 a[34:35], v9 offset:26624
    v_mfma_f32_16x16x32_bf16 v[92:95], a[12:15], a[80:83], v[92:95]
    ds_read_b64_tr_b16 a[36:37], v10 offset:24576
    ds_read_b64_tr_b16 a[38:39], v10 offset:26624
    ds_read_b32 v17, v14 offset:32
    v_mfma_f32_16x16x32_bf16 v[80:83], a[16:19], a[84:87], v[80:83]
    ds_read_b64_tr_b16 a[40:41], v11 offset:24576
    ds_read_b64_tr_b16 a[42:43], v11 offset:26624
    buffer_load_dwordx4 v8, s[20:23], s35 offen offset:3072  lds
    v_mfma_f32_16x16x32_bf16 v[84:87], a[20:23], a[84:87], v[84:87]
    ds_read_b64_tr_b16 a[44:45], v12 offset:24576
    ds_read_b64_tr_b16 a[46:47], v12 offset:26624
    s_mov_b32 m0, s34
    v_mfma_f32_16x16x32_bf16 v[88:91], a[24:27], a[84:87], v[88:91]
    s_add_u32 s34, s34, 1
    v_mfma_f32_16x16x32_bf16 v[92:95], a[28:31], a[84:87], v[92:95]
    s_movrels_b32 s35, s64
    s_waitcnt lgkmcnt(4)
    v_cmp_ne_u32 vcc, s39, v17
    s_cbranch_vccnz L_slowcb16
L_retcb16:
    ds_read_b128 a[64:67], v13 offset:10240
    ds_read_b128 a[84:87], v13 offset:15360
    v_mfma_f32_16x16x32_bf16 v[96:99], a[0:3], a[88:91], v[96:99]
    s_waitcnt lgkmcnt(2)
    s_add_u32 m0, s31, 24576
    ds_read_b128 a[68:71], v13 offset:11264
    v_mfma_f32_16x16x32_bf16 v[100:103], a[4:7], a[88:91], v[100:103]
    buffer_load_dwordx4 v1, s[20:23], s35 offen offset:0  lds
    ds_read_b128 a[72:75], v13 offset:12288
    v_mfma_f32_16x16x32_bf16 v[104:107], a[8:11], a[88:91], v[104:107]
    ds_read_b128 a[76:79], v13 offset:13312
    v_mfma_f32_16x16x32_bf16 v[108:111], a[12:15], a[88:91], v[108:111]
    ds_read_b128 a[80:83], v13 offset:14336
    ds_read_b128 a[88:91], v13 offset:16384
    v_mfma_f32_16x16x32_bf16 v[96:99], a[16:19], a[92:95], v[96:99]
    v_mfma_f32_16x16x32_bf16 v[100:103], a[20:23], a[92:95], v[100:103]
    v_mfma_f32_16x16x32_bf16 v[104:107], a[24:27], a[92:95], v[104:107]
    buffer_load_dwordx4 v2, s[20:23], s35 offen offset:1024  lds
    v_mfma_f32_16x16x32_bf16 v[108:111], a[28:31], a[92:95], v[108:111]
    ds_read_b128 a[92:95], v13 offset:17408
    v_mfma_f32_16x16x32_bf16 v[112:115], a[0:3], a[96:99], v[112:115]
    s_waitcnt vmcnt(10)
    ds_read_b64_tr_b16 a[48:49], v9 offset:28672
    ds_read_b64_tr_b16 a[50:51], v9 offset:30720
    v_mfma_f32_16x16x32_bf16 v[116:119], a[4:7], a[96:99], v[116:119]
    ds_read_b64_tr_b16 a[52:53], v10 offset:28672
    ds_read_b64_tr_b16 a[54:55], v10 offset:30720
    v_mfma_f32_16x16x32_bf16 v[120:123], a[8:11], a[96:99], v[120:123]
    ds_read_b64_tr_b16 a[56:57], v11 offset:28672
    ds_read_b64_tr_b16 a[58:59], v11 offset:30720
    v_mfma_f32_16x16x32_bf16 v[124:127], a[12:15], a[96:99], v[124:127]
    ds_read_b64_tr_b16 a[60:61], v12 offset:28672
    ds_read_b64_tr_b16 a[62:63], v12 offset:30720
    buffer_load_dwordx4 v3, s[20:23], s35 offen offset:2048  lds
    v_mfma_f32_16x16x32_bf16 v[112:115], a[16:19], a[100:103], v[112:115]
    v_mfma_f32_16x16x32_bf16 v[116:119], a[20:23], a[100:103], v[116:119]
    v_mfma_f32_16x16x32_bf16 v[120:123], a[24:27], a[100:103], v[120:123]
    v_mfma_f32_16x16x32_bf16 v[124:127], a[28:31], a[100:103], v[124:127]
    s_waitcnt lgkmcnt(0)
    s_cmp_eq_u32 s38, 7
    s_cbranch_scc1 L_epB_5
    v_mfma_f32_16x16x32_bf16 v[48:51], a[32:35], a[64:67], v[48:51]
    ds_read_b128 a[96:99], v13 offset:18432
    ds_read_b128 a[100:103], v13 offset:19456
    buffer_load_dwordx4 v4, s[20:23], s35 offen offset:3072  lds
    v_mfma_f32_16x16x32_bf16 v[52:55], a[36:39], a[64:67], v[52:55]
    s_add_u32 s39, s39, 1
    v_mfma_f32_16x16x32_bf16 v[56:59], a[40:43], a[64:67], v[56:59]
    v_mov_b32 v16, s39
    v_mfma_f32_16x16x32_bf16 v[60:63], a[44:47], a[64:67], v[60:63]
    ds_write_b32 v15, v16 offset:16
    v_mfma_f32_16x16x32_bf16 v[48:51], a[48:51], a[68:71], v[48:51]
    s_add_u32 m0, s31, 28672
    v_mfma_f32_16x16x32_bf16 v[52:55], a[52:55], a[68:71], v[52:55]
    buffer_load_dwordx4 v5, s[20:23], s35 offen offset:0  lds
    v_mfma_f32_16x16x32_bf16 v[56:59], a[56:59], a[68:71], v[56:59]
    v_mfma_f32_16x16x32_bf16 v[60:63], a[60:63], a[68:71], v[60:63]
    v_mfma_f32_16x16x32_bf16 v[64:67], a[32:35], a[72:75], v[64:67]
    v_mfma_f32_16x16x32_bf16 v[68:71], a[36:39], a[72:75], v[68:71]
    v_mfma_f32_16x16x32_bf16 v[72:75], a[40:43], a[72:75], v[72:75]
    buffer_load_dwordx4 v6, s[20:23], s35 offen offset:1024  lds
    v_mfma_f32_16x16x32_bf16 v[76:79], a[44:47], a[72:75], v[76:79]
    v_mfma_f32_16x16x32_bf16 v[64:67], a[48:51], a[76:79], v[64:67]
    v_mfma_f32_16x16x32_bf16 v[68:71], a[52:55], a[76:79], v[68:71]
    v_mfma_f32_16x16x32_bf16 v[72:75], a[56:59], a[76:79], v[72:75]
    v_mfma_f32_16x16x32_bf16 v[76:79], a[60:63], a[76:79], v[76:79]
    buffer_load_dwordx4 v7, s[20:23], s35 offen offset:2048  lds
    v_mfma_f32_16x16x32_bf16 v[80:83], a[32:35], a[80:83], v[80:83]
    v_mfma_f32_16x16x32_bf16 v[84:87], a[36:39], a[80:83], v[84:87]
    v_mfma_f32_16x16x32_bf16 v[88:91], a[40:43], a[80:83], v[88:91]
    s_waitcnt vmcnt(11)
    ds_read_b64_tr_b16 a[0:1], v9 offset:16384
    ds_read_b64_tr_b16 a[2:3], v9 offset:18432
    v_mfma_f32_16x16x32_bf16 v[92:95], a[44:47], a[80:83], v[92:95]
    ds_read_b64_tr_b16 a[4:5], v10 offset:16384
    ds_read_b64_tr_b16 a[6:7], v10 offset:18432
    ds_read_b32 v17, v14 offset:0
    v_mfma_f32_16x16x32_bf16 v[80:83], a[48:51], a[84:87], v[80:83]
    ds_read_b64_tr_b16 a[8:9], v11 offset:16384
    ds_read_b64_tr_b16 a[10:11], v11 offset:18432
    buffer_load_dwordx4 v8, s[20:23], s35 offen offset:3072  lds
    v_mfma_f32_16x16x32_bf16 v[84:87], a[52:55], a[84:87], v[84:87]
    ds_read_b64_tr_b16 a[12:13], v12 offset:16384
    ds_read_b64_tr_b16 a[14:15], v12 offset:18432
    s_mov_b32 m0, s34
    v_mfma_f32_16x16x32_bf16 v[88:91], a[56:59], a[84:87], v[88:91]
    s_add_u32 s34, s34, 1
    v_mfma_f32_16x16x32_bf16 v[92:95], a[60:63], a[84:87], v[92:95]
    s_movrels_b32 s35, s64
    s_waitcnt lgkmcnt(4)
    v_cmp_ne_u32 vcc, s39, v17
    s_cbranch_vccnz L_slowcb17
L_retcb17:
    ds_read_b128 a[64:67], v13 offset:0
    ds_read_b128 a[84:87], v13 offset:5120
    v_mfma_f32_16x16x32_bf16 v[96:99], a[32:35], a[88:91], v[96:99]
    s_waitcnt lgkmcnt(2)
    s_add_u32 m0, s31, 16384
    ds_read_b128 a[68:71], v13 offset:1024
    v_mfma_f32_16x16x32_bf16 v[100:103], a[36:39], a[88:91], v[100:103]
    buffer_load_dwordx4 v1, s[20:23], s35 offen offset:0  lds
    ds_read_b128 a[72:75], v13 offset:2048
    v_mfma_f32_16x16x32_bf16 v[104:107], a[40:43], a[88:91], v[104:107]
    ds_read_b128 a[76:79], v13 offset:3072
    v_mfma_f32_16x16x32_bf16 v[108:111], a[44:47], a[88:91], v[108:111]
    ds_read_b128 a[80:83], v13 offset:4096
    ds_read_b128 a[88:91], v13 offset:6144
    v_mfma_f32_16x16x32_bf16 v[96:99], a[48:51], a[92:95], v[96:99]
    v_mfma_f32_16x16x32_bf16 v[100:103], a[52:55], a[92:95], v[100:103]
    v_mfma_f32_16x16x32_bf16 v[104:107], a[56:59], a[92:95], v[104:107]
    buffer_load_dwordx4 v2, s[20:23], s35 offen offset:1024  lds
    v_mfma_f32_16x16x32_bf16 v[108:111], a[60:63], a[92:95], v[108:111]
    ds_read_b128 a[92:95], v13 offset:7168
    v_mfma_f32_16x16x32_bf16 v[112:115], a[32:35], a[96:99], v[112:115]
    s_waitcnt vmcnt(10)
    ds_read_b64_tr_b16 a[16:17], v9 offset:20480
    ds_read_b64_tr_b16 a[18:19], v9 offset:22528
    v_mfma_f32_16x16x32_bf16 v[116:119], a[36:39], a[96:99], v[116:119]
    ds_read_b64_tr_b16 a[20:21], v10 offset:20480
    ds_read_b64_tr_b16 a[22:23], v10 offset:22528
    v_mfma_f32_16x16x32_bf16 v[120:123], a[40:43], a[96:99], v[120:123]
    ds_read_b64_tr_b16 a[24:25], v11 offset:20480
    ds_read_b64_tr_b16 a[26:27], v11 offset:22528
    v_mfma_f32_16x16x32_bf16 v[124:127], a[44:47], a[96:99], v[124:127]
    ds_read_b64_tr_b16 a[28:29], v12 offset:20480
    ds_read_b64_tr_b16 a[30:31], v12 offset:22528
    buffer_load_dwordx4 v3, s[20:23], s35 offen offset:2048  lds
    v_mfma_f32_16x16x32_bf16 v[112:115], a[48:51], a[100:103], v[112:115]
    v_mfma_f32_16x16x32_bf16 v[116:119], a[52:55], a[100:103], v[116:119]
    v_mfma_f32_16x16x32_bf16 v[120:123], a[56:59], a[100:103], v[120:123]
    v_mfma_f32_16x16x32_bf16 v[124:127], a[60:63], a[100:103], v[124:127]
    s_waitcnt lgkmcnt(0)
    s_add_u32 s38, s38, 1
    s_branch L_loopB_5
L_epB_5:
    s_waitcnt lgkmcnt(0)
    v_mfma_f32_16x16x32_bf16 v[48:51], a[32:35], a[64:67], v[48:51]
    ds_read_b128 a[96:99], v13 offset:18432
    ds_read_b128 a[100:103], v13 offset:19456
    v_mfma_f32_16x16x32_bf16 v[52:55], a[36:39], a[64:67], v[52:55]
    s_add_u32 s39, s39, 1
    s_barrier
    ds_read_b128 v[28:31], v19 offset:2816
    ds_read_b128 v[32:35], v19 offset:3072
    ds_read_b128 v[36:39], v19 offset:3328
    ds_read_b128 v[40:43], v19 offset:3584
    ds_read_b128 v[44:47], v19 offset:3840
    v_mfma_f32_16x16x32_bf16 v[56:59], a[40:43], a[64:67], v[56:59]
    v_mov_b32 v16, s39
    v_mfma_f32_16x16x32_bf16 v[60:63], a[44:47], a[64:67], v[60:63]
    ds_write_b32 v15, v16 offset:16
    v_mfma_f32_16x16x32_bf16 v[48:51], a[48:51], a[68:71], v[48:51]
    v_mfma_f32_16x16x32_bf16 v[52:55], a[52:55], a[68:71], v[52:55]
    s_waitcnt lgkmcnt(5)
    v_add_f32 v28, v28, v29
    v_add_f32 v30, v30, v31
    v_add_f32 v28, v28, v30
    v_rcp_f32 v20, v28
    s_waitcnt lgkmcnt(4)
    v_add_f32 v32, v32, v33
    v_mfma_f32_16x16x32_bf16 v[56:59], a[56:59], a[68:71], v[56:59]
    v_add_f32 v34, v34, v35
    v_add_f32 v32, v32, v34
    v_rcp_f32 v21, v32
    s_waitcnt lgkmcnt(3)
    v_add_f32 v36, v36, v37
    v_add_f32 v38, v38, v39
    v_mfma_f32_16x16x32_bf16 v[60:63], a[60:63], a[68:71], v[60:63]
    v_add_f32 v36, v36, v38
    v_rcp_f32 v22, v36
    s_waitcnt lgkmcnt(2)
    v_add_f32 v40, v40, v41
    v_add_f32 v42, v42, v43
    v_add_f32 v40, v40, v42
    v_mfma_f32_16x16x32_bf16 v[64:67], a[32:35], a[72:75], v[64:67]
    v_rcp_f32 v23, v40
    s_waitcnt lgkmcnt(1)
    v_add_f32 v44, v44, v45
    v_add_f32 v46, v46, v47
    v_add_f32 v44, v44, v46
    v_mfma_f32_16x16x32_bf16 v[68:71], a[36:39], a[72:75], v[68:71]
    v_rcp_f32 v24, v44
    v_mfma_f32_16x16x32_bf16 v[72:75], a[40:43], a[72:75], v[72:75]
    v_mul_f32 v48, v48, v20
    v_mul_f32 v49, v49, v20
    v_mul_f32 v50, v50, v20
    v_mul_f32 v51, v51, v20
    v_mul_f32 v52, v52, v20
    v_mfma_f32_16x16x32_bf16 v[76:79], a[44:47], a[72:75], v[76:79]
    v_mul_f32 v53, v53, v20
    v_mul_f32 v54, v54, v20
    v_mul_f32 v55, v55, v20
    v_cvt_pk_bf16_f32 v48, v48, v49
    v_mfma_f32_16x16x32_bf16 v[64:67], a[48:51], a[76:79], v[64:67]
    v_cvt_pk_bf16_f32 v49, v50, v51
    v_cvt_pk_bf16_f32 v50, v52, v53
    v_cvt_pk_bf16_f32 v51, v54, v55
    s_nop 0
    v_permlane16_swap_b32 v48, v50
    v_permlane16_swap_b32 v49, v51
    v_mfma_f32_16x16x32_bf16 v[68:71], a[52:55], a[76:79], v[68:71]
    s_nop 0
    buffer_store_dwordx4 v[48:51], v18, s[24:27], 0 offen offset:0 nt
    v_mul_f32 v56, v56, v20
    v_mul_f32 v57, v57, v20
    v_mfma_f32_16x16x32_bf16 v[72:75], a[56:59], a[76:79], v[72:75]
    v_mul_f32 v58, v58, v20
    v_mul_f32 v59, v59, v20
    v_mul_f32 v60, v60, v20
    v_mul_f32 v61, v61, v20
    v_mul_f32 v62, v62, v20
    v_mfma_f32_16x16x32_bf16 v[76:79], a[60:63], a[76:79], v[76:79]
    v_mul_f32 v63, v63, v20
    v_cvt_pk_bf16_f32 v56, v56, v57
    v_cvt_pk_bf16_f32 v57, v58, v59
    v_cvt_pk_bf16_f32 v58, v60, v61
    v_mfma_f32_16x16x32_bf16 v[80:83], a[32:35], a[80:83], v[80:83]
    v_cvt_pk_bf16_f32 v59, v62, v63
    v_permlane16_swap_b32 v56, v58
    s_nop 0
    v_permlane16_swap_b32 v57, v59
    s_nop 0
    v_mfma_f32_16x16x32_bf16 v[84:87], a[36:39], a[80:83], v[84:87]
    buffer_store_dwordx4 v[56:59], v18, s[24:27], 0 offen offset:64 nt
    v_mfma_f32_16x16x32_bf16 v[88:91], a[40:43], a[80:83], v[88:91]
    v_mul_f32 v64, v64, v21
    v_mul_f32 v65, v65, v21
    v_mul_f32 v66, v66, v21
    v_mul_f32 v67, v67, v21
    v_mul_f32 v68, v68, v21
    v_mfma_f32_16x16x32_bf16 v[92:95], a[44:47], a[80:83], v[92:95]
    v_mul_f32 v69, v69, v21
    v_mul_f32 v70, v70, v21
    v_mul_f32 v71, v71, v21
    v_cvt_pk_bf16_f32 v64, v64, v65
    v_mfma_f32_16x16x32_bf16 v[80:83], a[48:51], a[84:87], v[80:83]
    v_cvt_pk_bf16_f32 v65, v66, v67
    v_cvt_pk_bf16_f32 v66, v68, v69
    v_cvt_pk_bf16_f32 v67, v70, v71
    s_nop 0
    v_permlane16_swap_b32 v64, v66
    v_permlane16_swap_b32 v65, v67
    v_mfma_f32_16x16x32_bf16 v[84:87], a[52:55], a[84:87], v[84:87]
    s_nop 0
    buffer_store_dwordx4 v[64:67], v18, s[24:27], s51 offen offset:0 nt
    v_mul_f32 v72, v72, v21
    v_mul_f32 v73, v73, v21
    v_mfma_f32_16x16x32_bf16 v[88:91], a[56:59], a[84:87], v[88:91]
    v_mul_f32 v74, v74, v21
    v_mul_f32 v75, v75, v21
    v_mul_f32 v76, v76, v21
    v_mul_f32 v77, v77, v21
    v_mul_f32 v78, v78, v21
    v_mfma_f32_16x16x32_bf16 v[92:95], a[60:63], a[84:87], v[92:95]
    v_mul_f32 v79, v79, v21
    v_cvt_pk_bf16_f32 v72, v72, v73
    v_cvt_pk_bf16_f32 v73, v74, v75
    v_cvt_pk_bf16_f32 v74, v76, v77
    v_mfma_f32_16x16x32_bf16 v[96:99], a[32:35], a[88:91], v[96:99]
    v_cvt_pk_bf16_f32 v75, v78, v79
    v_permlane16_swap_b32 v72, v74
    s_nop 0
    v_permlane16_swap_b32 v73, v75
    s_nop 0
    v_mfma_f32_16x16x32_bf16 v[100:103], a[36:39], a[88:91], v[100:103]
    buffer_store_dwordx4 v[72:75], v18, s[24:27], s51 offen offset:64 nt
    v_mfma_f32_16x16x32_bf16 v[104:107], a[40:43], a[88:91], v[104:107]
    v_mul_f32 v80, v80, v22
    v_mul_f32 v81, v81, v22
    v_mul_f32 v82, v82, v22
    v_mul_f32 v83, v83, v22
    v_mul_f32 v84, v84, v22
    v_mfma_f32_16x16x32_bf16 v[108:111], a[44:47], a[88:91], v[108:111]
    v_mul_f32 v85, v85, v22
    v_mul_f32 v86, v86, v22
    v_mul_f32 v87, v87, v22
    v_cvt_pk_bf16_f32 v80, v80, v81
    v_mfma_f32_16x16x32_bf16 v[96:99], a[48:51], a[92:95], v[96:99]
    v_cvt_pk_bf16_f32 v81, v82, v83
    v_cvt_pk_bf16_f32 v82, v84, v85
    v_cvt_pk_bf16_f32 v83, v86, v87
    s_nop 0
    v_permlane16_swap_b32 v80, v82
    v_permlane16_swap_b32 v81, v83
    v_mfma_f32_16x16x32_bf16 v[100:103], a[52:55], a[92:95], v[100:103]
    s_nop 0
    buffer_store_dwordx4 v[80:83], v18, s[24:27], s52 offen offset:0 nt
    v_mul_f32 v88, v88, v22
    v_mul_f32 v89, v89, v22
    v_mfma_f32_16x16x32_bf16 v[104:107], a[56:59], a[92:95], v[104:107]
    v_mul_f32 v90, v90, v22
    v_mul_f32 v91, v91, v22
    v_mul_f32 v92, v92, v22
    v_mul_f32 v93, v93, v22
    v_mul_f32 v94, v94, v22
    v_mfma_f32_16x16x32_bf16 v[108:111], a[60:63], a[92:95], v[108:111]
    v_mul_f32 v95, v95, v22
    v_cvt_pk_bf16_f32 v88, v88, v89
    v_cvt_pk_bf16_f32 v89, v90, v91
    v_cvt_pk_bf16_f32 v90, v92, v93
    v_mfma_f32_16x16x32_bf16 v[112:115], a[32:35], a[96:99], v[112:115]
    v_cvt_pk_bf16_f32 v91, v94, v95
    v_permlane16_swap_b32 v88, v90
    s_nop 0
    v_permlane16_swap_b32 v89, v91
    s_nop 0
    v_mfma_f32_16x16x32_bf16 v[116:119], a[36:39], a[96:99], v[116:119]
    buffer_store_dwordx4 v[88:91], v18, s[24:27], s52 offen offset:64 nt
    v_mfma_f32_16x16x32_bf16 v[120:123], a[40:43], a[96:99], v[120:123]
    v_mul_f32 v96, v96, v23
    v_mul_f32 v97, v97, v23
    v_mul_f32 v98, v98, v23
    v_mul_f32 v99, v99, v23
    v_mul_f32 v100, v100, v23
    v_mul_f32 v101, v101, v23
    v_mul_f32 v102, v102, v23
    v_mfma_f32_16x16x32_bf16 v[124:127], a[44:47], a[96:99], v[124:127]
    v_mul_f32 v103, v103, v23
    v_cvt_pk_bf16_f32 v96, v96, v97
    v_cvt_pk_bf16_f32 v97, v98, v99
    v_cvt_pk_bf16_f32 v98, v100, v101
    v_cvt_pk_bf16_f32 v99, v102, v103
    s_nop 0
    v_permlane16_swap_b32 v96, v98
    v_mfma_f32_16x16x32_bf16 v[112:115], a[48:51], a[100:103], v[112:115]
    v_permlane16_swap_b32 v97, v99
    s_nop 0
    buffer_store_dwordx4 v[96:99], v18, s[24:27], s53 offen offset:0 nt
    v_mul_f32 v104, v104, v23
    v_mul_f32 v105, v105, v23
    v_mul_f32 v106, v106, v23
    v_mfma_f32_16x16x32_bf16 v[116:119], a[52:55], a[100:103], v[116:119]
    v_mul_f32 v107, v107, v23
    v_mul_f32 v108, v108, v23
    v_mul_f32 v109, v109, v23
    v_mul_f32 v110, v110, v23
    v_mul_f32 v111, v111, v23
    v_cvt_pk_bf16_f32 v104, v104, v105
    v_mfma_f32_16x16x32_bf16 v[120:123], a[56:59], a[100:103], v[120:123]
    v_cvt_pk_bf16_f32 v105, v106, v107
    v_cvt_pk_bf16_f32 v106, v108, v109
    v_cvt_pk_bf16_f32 v107, v110, v111
    s_nop 0
    v_permlane16_swap_b32 v104, v106
    v_permlane16_swap_b32 v105, v107
    s_nop 0
    v_mfma_f32_16x16x32_bf16 v[124:127], a[60:63], a[100:103], v[124:127]
    buffer_store_dwordx4 v[104:107], v18, s[24:27], s53 offen offset:64 nt
    v_mul_f32 v112, v112, v24
    v_mul_f32 v113, v113, v24
    v_mul_f32 v114, v114, v24
    v_mul_f32 v115, v115, v24
    v_mul_f32 v116, v116, v24
    v_mul_f32 v117, v117, v24
    v_mul_f32 v118, v118, v24
    v_mul_f32 v119, v119, v24
    v_cvt_pk_bf16_f32 v112, v112, v113
    v_cvt_pk_bf16_f32 v113, v114, v115
    v_cvt_pk_bf16_f32 v114, v116, v117
    v_cvt_pk_bf16_f32 v115, v118, v119
    s_nop 0
    v_permlane16_swap_b32 v112, v114
    v_permlane16_swap_b32 v113, v115
    s_nop 0
    buffer_store_dwordx4 v[112:115], v18, s[24:27], s54 offen offset:0 nt
    v_mul_f32 v120, v120, v24
    v_mul_f32 v121, v121, v24
    v_mul_f32 v122, v122, v24
    v_mul_f32 v123, v123, v24
    v_mul_f32 v124, v124, v24
    v_mul_f32 v125, v125, v24
    v_mul_f32 v126, v126, v24
    v_mul_f32 v127, v127, v24
    v_cvt_pk_bf16_f32 v120, v120, v121
    v_cvt_pk_bf16_f32 v121, v122, v123
    v_cvt_pk_bf16_f32 v122, v124, v125
    v_cvt_pk_bf16_f32 v123, v126, v127
    s_nop 0
    v_permlane16_swap_b32 v120, v122
    v_permlane16_swap_b32 v121, v123
    s_nop 0
    buffer_store_dwordx4 v[120:123], v18, s[24:27], s54 offen offset:64 nt
    s_branch L_end
L_roleB4:
    s_add_u32 m0, s31, 16384
    s_nop 0
    buffer_load_dwordx4 v1, s[20:23], s35 offen offset:0  lds
    buffer_load_dwordx4 v2, s[20:23], s35 offen offset:1024  lds
    buffer_load_dwordx4 v3, s[20:23], s35 offen offset:2048  lds
    buffer_load_dwordx4 v4, s[20:23], s35 offen offset:3072  lds
L_mpollB_4:
    ds_read_b32 v17, v14 offset:80
    s_waitcnt lgkmcnt(0)
    v_cmp_ne_u32 vcc, 1, v17
    s_cbranch_vccnz L_mpollB_4
    ds_read_b128 v[28:31], v19 offset:2816
    ds_read_b128 v[32:35], v19 offset:3072
    ds_read_b128 v[36:39], v19 offset:3328
    ds_read_b128 v[44:47], v19 offset:3584
    s_waitcnt lgkmcnt(3)
    v_max3_f32 v28, v28, v29, v30
    v_max_f32 v20, v28, v31
    s_waitcnt lgkmcnt(2)
    v_max3_f32 v32, v32, v33, v34
    v_max_f32 v21, v32, v35
    s_waitcnt lgkmcnt(1)
    v_max3_f32 v36, v36, v37, v38
    v_max_f32 v22, v36, v39
    s_waitcnt lgkmcnt(0)
    v_max3_f32 v44, v44, v45, v46
    v_max_f32 v23, v44, v47
    ds_read_b32 v17, v14 offset:0
    s_waitcnt lgkmcnt(0)
    v_cmp_ne_u32 vcc, s39, v17
    s_cbranch_vccnz L_slowcb19
L_retcb19:
    ds_read_b128 a[64:67], v13 offset:0
    ds_read_b128 a[68:71], v13 offset:1024
    ds_read_b128 a[72:75], v13 offset:2048
    ds_read_b128 a[76:79], v13 offset:3072
    ds_read_b128 a[80:83], v13 offset:4096
    ds_read_b128 a[84:87], v13 offset:5120
    s_waitcnt lgkmcnt(0)
    s_nop 3
    s_mov_b32 s38, 0
.p2align 3
L_loopB_4:
    v_mfma_f32_16x16x32_bf16 v[48:51], a[0:3], a[64:67], v[48:51]
    ds_read_b128 a[88:91], v13 offset:6144
    ds_read_b128 a[92:95], v13 offset:7168
    v_mfma_f32_16x16x32_bf16 v[52:55], a[4:7], a[64:67], v[52:55]
    s_add_u32 s39, s39, 1
    v_mfma_f32_16x16x32_bf16 v[56:59], a[8:11], a[64:67], v[56:59]
    v_mov_b32 v16, s39
    s_add_u32 m0, s31, 20480
    v_mfma_f32_16x16x32_bf16 v[60:63], a[12:15], a[64:67], v[60:63]
    ds_write_b32 v15, v16 offset:48
    buffer_load_dwordx4 v5, s[20:23], s35 offen offset:0  lds
    v_mfma_f32_16x16x32_bf16 v[48:51], a[16:19], a[68:71], v[48:51]
    v_mfma_f32_16x16x32_bf16 v[52:55], a[20:23], a[68:71], v[52:55]
    v_mfma_f32_16x16x32_bf16 v[56:59], a[24:27], a[68:71], v[56:59]
    v_mfma_f32_16x16x32_bf16 v[60:63], a[28:31], a[68:71], v[60:63]
    buffer_load_dwordx4 v6, s[20:23], s35 offen offset:1024  lds
    v_mfma_f32_16x16x32_bf16 v[64:67], a[0:3], a[72:75], v[64:67]
    v_mfma_f32_16x16x32_bf16 v[68:71], a[4:7], a[72:75], v[68:71]
    v_mfma_f32_16x16x32_bf16 v[72:75], a[8:11], a[72:75], v[72:75]
    v_mfma_f32_16x16x32_bf16 v[76:79], a[12:15], a[72:75], v[76:79]
    buffer_load_dwordx4 v7, s[20:23], s35 offen offset:2048  lds
    ds_read_b32 v17, v14 offset:32
    v_mfma_f32_16x16x32_bf16 v[64:67], a[16:19], a[76:79], v[64:67]
    v_mfma_f32_16x16x32_bf16 v[68:71], a[20:23], a[76:79], v[68:71]
    v_mfma_f32_16x16x32_bf16 v[72:75], a[24:27], a[76:79], v[72:75]
    s_waitcnt vmcnt(11)
    ds_read_b64_tr_b16 a[32:33], v9 offset:24576
    ds_read_b64_tr_b16 a[34:35], v9 offset:26624
    v_mfma_f32_16x16x32_bf16 v[76:79], a[28:31], a[76:79], v[76:79]
    ds_read_b64_tr_b16 a[36:37], v10 offset:24576
    ds_read_b64_tr_b16 a[38:39], v10 offset:26624
    buffer_load_dwordx4 v8, s[20:23], s35 offen offset:3072  lds
    s_waitcnt lgkmcnt(4)
    v_cmp_ne_u32 vcc, s39, v17
    s_cbranch_vccnz L_slowcb22
L_retcb22:
    ds_read_b128 a[64:67], v13 offset:10240
    ds_read_b128 a[76:79], v13 offset:13312
    v_mfma_f32_16x16x32_bf16 v[80:83], a[0:3], a[80:83], v[80:83]
    ds_read_b64_tr_b16 a[40:41], v11 offset:24576
    ds_read_b64_tr_b16 a[42:43], v11 offset:26624
    s_mov_b32 m0, s34
    ds_read_b128 a[68:71], v13 offset:11264
    v_mfma_f32_16x16x32_bf16 v[84:87], a[4:7], a[80:83], v[84:87]
    ds_read_b64_tr_b16 a[44:45], v12 offset:24576
    ds_read_b64_tr_b16 a[46:47], v12 offset:26624
    s_add_u32 s34, s34, 1
    ds_read_b128 a[72:75], v13 offset:12288
    v_mfma_f32_16x16x32_bf16 v[88:91], a[8:11], a[80:83], v[88:91]
    s_movrels_b32 s35, s64
    v_mfma_f32_16x16x32_bf16 v[92:95], a[12:15], a[80:83], v[92:95]
    s_waitcnt lgkmcnt(0)
    s_add_u32 m0, s31, 24576
    ds_read_b128 a[80:83], v13 offset:14336
    v_mfma_f32_16x16x32_bf16 v[80:83], a[16:19], a[84:87], v[80:83]
    buffer_load_dwordx4 v1, s[20:23], s35 offen offset:0  lds
    v_mfma_f32_16x16x32_bf16 v[84:87], a[20:23], a[84:87], v[84:87]
    v_mfma_f32_16x16x32_bf16 v[88:91], a[24:27], a[84:87], v[88:91]
    v_mfma_f32_16x16x32_bf16 v[92:95], a[28:31], a[84:87], v[92:95]
    buffer_load_dwordx4 v2, s[20:23], s35 offen offset:1024  lds
    ds_read_b128 a[84:87], v13 offset:15360
    v_mfma_f32_16x16x32_bf16 v[96:99], a[0:3], a[88:91], v[96:99]
    s_waitcnt vmcnt(10)
    ds_read_b64_tr_b16 a[48:49], v9 offset:28672
    ds_read_b64_tr_b16 a[50:51], v9 offset:30720
    v_mfma_f32_16x16x32_bf16 v[100:103], a[4:7], a[88:91], v[100:103]
    ds_read_b64_tr_b16 a[52:53], v10 offset:28672
    ds_read_b64_tr_b16 a[54:55], v10 offset:30720
    v_mfma_f32_16x16x32_bf16 v[104:107], a[8:11], a[88:91], v[104:107]
    ds_read_b64_tr_b16 a[56:57], v11 offset:28672
    ds_read_b64_tr_b16 a[58:59], v11 offset:30720
    v_mfma_f32_16x16x32_bf16 v[108:111], a[12:15], a[88:91], v[108:111]
    ds_read_b64_tr_b16 a[60:61], v12 offset:28672
    ds_read_b64_tr_b16 a[62:63], v12 offset:30720
    buffer_load_dwordx4 v3, s[20:23], s35 offen offset:2048  lds
    v_mfma_f32_16x16x32_bf16 v[96:99], a[16:19], a[92:95], v[96:99]
    v_mfma_f32_16x16x32_bf16 v[100:103], a[20:23], a[92:95], v[100:103]
    v_mfma_f32_16x16x32_bf16 v[104:107], a[24:27], a[92:95], v[104:107]
    v_mfma_f32_16x16x32_bf16 v[108:111], a[28:31], a[92:95], v[108:111]
    s_waitcnt lgkmcnt(0)
    buffer_load_dwordx4 v4, s[20:23], s35 offen offset:3072  lds
    s_cmp_eq_u32 s38, 7
    s_cbranch_scc1 L_epB_4
    v_mfma_f32_16x16x32_bf16 v[48:51], a[32:35], a[64:67], v[48:51]
    ds_read_b128 a[88:91], v13 offset:16384
    ds_read_b128 a[92:95], v13 offset:17408
    v_mfma_f32_16x16x32_bf16 v[52:55], a[36:39], a[64:67], v[52:55]
    s_add_u32 s39, s39, 1
    v_mfma_f32_16x16x32_bf16 v[56:59], a[40:43], a[64:67], v[56:59]
    v_mov_b32 v16, s39
    s_add_u32 m0, s31, 28672
    v_mfma_f32_16x16x32_bf16 v[60:63], a[44:47], a[64:67], v[60:63]
    ds_write_b32 v15, v16 offset:16
    buffer_load_dwordx4 v5, s[20:23], s35 offen offset:0  lds
    v_mfma_f32_16x16x32_bf16 v[48:51], a[48:51], a[68:71], v[48:51]
    v_mfma_f32_16x16x32_bf16 v[52:55], a[52:55], a[68:71], v[52:55]
    v_mfma_f32_16x16x32_bf16 v[56:59], a[56:59], a[68:71], v[56:59]
    v_mfma_f32_16x16x32_bf16 v[60:63], a[60:63], a[68:71], v[60:63]
    buffer_load_dwordx4 v6, s[20:23], s35 offen offset:1024  lds
    v_mfma_f32_16x16x32_bf16 v[64:67], a[32:35], a[72:75], v[64:67]
    v_mfma_f32_16x16x32_bf16 v[68:71], a[36:39], a[72:75], v[68:71]
    v_mfma_f32_16x16x32_bf16 v[72:75], a[40:43], a[72:75], v[72:75]
    v_mfma_f32_16x16x32_bf16 v[76:79], a[44:47], a[72:75], v[76:79]
    buffer_load_dwordx4 v7, s[20:23], s35 offen offset:2048  lds
    ds_read_b32 v17, v14 offset:0
    v_mfma_f32_16x16x32_bf16 v[64:67], a[48:51], a[76:79], v[64:67]
    v_mfma_f32_16x16x32_bf16 v[68:71], a[52:55], a[76:79], v[68:71]
    v_mfma_f32_16x16x32_bf16 v[72:75], a[56:59], a[76:79], v[72:75]
    s_waitcnt vmcnt(11)
    ds_read_b64_tr_b16 a[0:1], v9 offset:16384
    ds_read_b64_tr_b16 a[2:3], v9 offset:18432
    v_mfma_f32_16x16x32_bf16 v[76:79], a[60:63], a[76:79], v[76:79]
    ds_read_b64_tr_b16 a[4:5], v10 offset:16384
    ds_read_b64_tr_b16 a[6:7], v10 offset:18432
    buffer_load_dwordx4 v8, s[20:23], s35 offen offset:3072  lds
    s_waitcnt lgkmcnt(4)
    v_cmp_ne_u32 vcc, s39, v17
    s_cbranch_vccnz L_slowcb23
L_retcb23:
    ds_read_b128 a[64:67], v13 offset:0
    ds_read_b128 a[76:79], v13 offset:3072
    v_mfma_f32_16x16x32_bf16 v[80:83], a[32:35], a[80:83], v[80:83]
    ds_read_b64_tr_b16 a[8:9], v11 offset:16384
    ds_read_b64_tr_b16 a[10:11], v11 offset:18432
    s_mov_b32 m0, s34
    ds_read_b128 a[68:71], v13 offset:1024
    v_mfma_f32_16x16x32_bf16 v[84:87], a[36:39], a[80:83], v[84:87]
    ds_read_b64_tr_b16 a[12:13], v12 offset:16384
    ds_read_b64_tr_b16 a[14:15], v12 offset:18432
    s_add_u32 s34, s34, 1
    ds_read_b128 a[72:75], v13 offset:2048
    v_mfma_f32_16x16x32_bf16 v[88:91], a[40:43], a[80:83], v[88:91]
    s_movrels_b32 s35, s64
    v_mfma_f32_16x16x32_bf16 v[92:95], a[44:47], a[80:83], v[92:95]
    s_waitcnt lgkmcnt(0)
    s_add_u32 m0, s31, 16384
    ds_read_b128 a[80:83], v13 offset:4096
    v_mfma_f32_16x16x32_bf16 v[80:83], a[48:51], a[84:87], v[80:83]
    buffer_load_dwordx4 v1, s[20:23], s35 offen offset:0  lds
    v_mfma_f32_16x16x32_bf16 v[84:87], a[52:55], a[84:87], v[84:87]
    v_mfma_f32_16x16x32_bf16 v[88:91], a[56:59], a[84:87], v[88:91]
    v_mfma_f32_16x16x32_bf16 v[92:95], a[60:63], a[84:87], v[92:95]
    buffer_load_dwordx4 v2, s[20:23], s35 offen offset:1024  lds
    ds_read_b128 a[84:87], v13 offset:5120
    v_mfma_f32_16x16x32_bf16 v[96:99], a[32:35], a[88:91], v[96:99]
    s_waitcnt vmcnt(10)
    ds_read_b64_tr_b16 a[16:17], v9 offset:20480
    ds_read_b64_tr_b16 a[18:19], v9 offset:22528
    v_mfma_f32_16x16x32_bf16 v[100:103], a[36:39], a[88:91], v[100:103]
    ds_read_b64_tr_b16 a[20:21], v10 offset:20480
    ds_read_b64_tr_b16 a[22:23], v10 offset:22528
    v_mfma_f32_16x16x32_bf16 v[104:107], a[40:43], a[88:91], v[104:107]
    ds_read_b64_tr_b16 a[24:25], v11 offset:20480
    ds_read_b64_tr_b16 a[26:27], v11 offset:22528
    v_mfma_f32_16x16x32_bf16 v[108:111], a[44:47], a[88:91], v[108:111]
    ds_read_b64_tr_b16 a[28:29], v12 offset:20480
    ds_read_b64_tr_b16 a[30:31], v12 offset:22528
    buffer_load_dwordx4 v3, s[20:23], s35 offen offset:2048  lds
    v_mfma_f32_16x16x32_bf16 v[96:99], a[48:51], a[92:95], v[96:99]
    v_mfma_f32_16x16x32_bf16 v[100:103], a[52:55], a[92:95], v[100:103]
    v_mfma_f32_16x16x32_bf16 v[104:107], a[56:59], a[92:95], v[104:107]
    v_mfma_f32_16x16x32_bf16 v[108:111], a[60:63], a[92:95], v[108:111]
    s_waitcnt lgkmcnt(0)
    buffer_load_dwordx4 v4, s[20:23], s35 offen offset:3072  lds
    s_add_u32 s38, s38, 1
    s_branch L_loopB_4
L_epB_4:
    s_waitcnt lgkmcnt(0)
    v_mfma_f32_16x16x32_bf16 v[48:51], a[32:35], a[64:67], v[48:51]
    ds_read_b128 a[88:91], v13 offset:16384
    ds_read_b128 a[92:95], v13 offset:17408
    v_mfma_f32_16x16x32_bf16 v[52:55], a[36:39], a[64:67], v[52:55]
    s_add_u32 s39, s39, 1
    s_barrier
    ds_read_b128 v[28:31], v19 offset:2816
    ds_read_b128 v[32:35], v19 offset:3072
    ds_read_b128 v[36:39], v19 offset:3328
    ds_read_b128 v[40:43], v19 offset:3584
    v_mfma_f32_16x16x32_bf16 v[56:59], a[40:43], a[64:67], v[56:59]
    v_mov_b32 v16, s39
    v_mfma_f32_16x16x32_bf16 v[60:63], a[44:47], a[64:67], v[60:63]
    ds_write_b32 v15, v16 offset:16
    v_mfma_f32_16x16x32_bf16 v[48:51], a[48:51], a[68:71], v[48:51]
    v_mfma_f32_16x16x32_bf16 v[52:55], a[52:55], a[68:71], v[52:55]
    s_waitcnt lgkmcnt(4)
    v_add_f32 v28, v28, v29
    v_add_f32 v30, v30, v31
    v_add_f32 v28, v28, v30
    v_rcp_f32 v20, v28
    v_mfma_f32_16x16x32_bf16 v[56:59], a[56:59], a[68:71], v[56:59]
    s_waitcnt lgkmcnt(3)
    v_add_f32 v32, v32, v33
    v_add_f32 v34, v34, v35
    v_add_f32 v32, v32, v34
    v_rcp_f32 v21, v32
    v_mfma_f32_16x16x32_bf16 v[60:63], a[60:63], a[68:71], v[60:63]
    s_waitcnt lgkmcnt(2)
    v_add_f32 v36, v36, v37
    v_add_f32 v38, v38, v39
    v_add_f32 v36, v36, v38
    v_rcp_f32 v22, v36
    v_mfma_f32_16x16x32_bf16 v[64:67], a[32:35], a[72:75], v[64:67]
    s_waitcnt lgkmcnt(1)
    v_add_f32 v40, v40, v41
    v_add_f32 v42, v42, v43
    v_add_f32 v40, v40, v42
    v_mfma_f32_16x16x32_bf16 v[68:71], a[36:39], a[72:75], v[68:71]
    v_rcp_f32 v23, v40
    v_mfma_f32_16x16x32_bf16 v[72:75], a[40:43], a[72:75], v[72:75]
    v_mul_f32 v48, v48, v20
    v_mul_f32 v49, v49, v20
    v_mul_f32 v50, v50, v20
    v_mul_f32 v51, v51, v20
    v_mul_f32 v52, v52, v20
    v_mfma_f32_16x16x32_bf16 v[76:79], a[44:47], a[72:75], v[76:79]
    v_mul_f32 v53, v53, v20
    v_mul_f32 v54, v54, v20
    v_mul_f32 v55, v55, v20
    v_cvt_pk_bf16_f32 v48, v48, v49
    v_mfma_f32_16x16x32_bf16 v[64:67], a[48:51], a[76:79], v[64:67]
    v_cvt_pk_bf16_f32 v49, v50, v51
    v_cvt_pk_bf16_f32 v50, v52, v53
    v_cvt_pk_bf16_f32 v51, v54, v55
    s_nop 0
    v_permlane16_swap_b32 v48, v50
    v_permlane16_swap_b32 v49, v51
    v_mfma_f32_16x16x32_bf16 v[68:71], a[52:55], a[76:79], v[68:71]
    s_nop 0
    buffer_store_dwordx4 v[48:51], v18, s[24:27], 0 offen offset:0 nt
    v_mul_f32 v56, v56, v20
    v_mul_f32 v57, v57, v20
    v_mfma_f32_16x16x32_bf16 v[72:75], a[56:59], a[76:79], v[72:75]
    v_mul_f32 v58, v58, v20
    v_mul_f32 v59, v59, v20
    v_mul_f32 v60, v60, v20
    v_mul_f32 v61, v61, v20
    v_mul_f32 v62, v62, v20
    v_mfma_f32_16x16x32_bf16 v[76:79], a[60:63], a[76:79], v[76:79]
    v_mul_f32 v63, v63, v20
    v_cvt_pk_bf16_f32 v56, v56, v57
    v_cvt_pk_bf16_f32 v57, v58, v59
    v_cvt_pk_bf16_f32 v58, v60, v61
    v_mfma_f32_16x16x32_bf16 v[80:83], a[32:35], a[80:83], v[80:83]
    v_cvt_pk_bf16_f32 v59, v62, v63
    v_permlane16_swap_b32 v56, v58
    s_nop 0
    v_permlane16_swap_b32 v57, v59
    s_nop 0
    v_mfma_f32_16x16x32_bf16 v[84:87], a[36:39], a[80:83], v[84:87]
    buffer_store_dwordx4 v[56:59], v18, s[24:27], 0 offen offset:64 nt
    v_mfma_f32_16x16x32_bf16 v[88:91], a[40:43], a[80:83], v[88:91]
    v_mul_f32 v64, v64, v21
    v_mul_f32 v65, v65, v21
    v_mul_f32 v66, v66, v21
    v_mul_f32 v67, v67, v21
    v_mul_f32 v68, v68, v21
    v_mfma_f32_16x16x32_bf16 v[92:95], a[44:47], a[80:83], v[92:95]
    v_mul_f32 v69, v69, v21
    v_mul_f32 v70, v70, v21
    v_mul_f32 v71, v71, v21
    v_cvt_pk_bf16_f32 v64, v64, v65
    v_mfma_f32_16x16x32_bf16 v[80:83], a[48:51], a[84:87], v[80:83]
    v_cvt_pk_bf16_f32 v65, v66, v67
    v_cvt_pk_bf16_f32 v66, v68, v69
    v_cvt_pk_bf16_f32 v67, v70, v71
    s_nop 0
    v_permlane16_swap_b32 v64, v66
    v_permlane16_swap_b32 v65, v67
    v_mfma_f32_16x16x32_bf16 v[84:87], a[52:55], a[84:87], v[84:87]
    s_nop 0
    buffer_store_dwordx4 v[64:67], v18, s[24:27], s51 offen offset:0 nt
    v_mul_f32 v72, v72, v21
    v_mul_f32 v73, v73, v21
    v_mfma_f32_16x16x32_bf16 v[88:91], a[56:59], a[84:87], v[88:91]
    v_mul_f32 v74, v74, v21
    v_mul_f32 v75, v75, v21
    v_mul_f32 v76, v76, v21
    v_mul_f32 v77, v77, v21
    v_mul_f32 v78, v78, v21
    v_mfma_f32_16x16x32_bf16 v[92:95], a[60:63], a[84:87], v[92:95]
    v_mul_f32 v79, v79, v21
    v_cvt_pk_bf16_f32 v72, v72, v73
    v_cvt_pk_bf16_f32 v73, v74, v75
    v_cvt_pk_bf16_f32 v74, v76, v77
    v_mfma_f32_16x16x32_bf16 v[96:99], a[32:35], a[88:91], v[96:99]
    v_cvt_pk_bf16_f32 v75, v78, v79
    v_permlane16_swap_b32 v72, v74
    s_nop 0
    v_permlane16_swap_b32 v73, v75
    s_nop 0
    v_mfma_f32_16x16x32_bf16 v[100:103], a[36:39], a[88:91], v[100:103]
    buffer_store_dwordx4 v[72:75], v18, s[24:27], s51 offen offset:64 nt
    v_mfma_f32_16x16x32_bf16 v[104:107], a[40:43], a[88:91], v[104:107]
    v_mul_f32 v80, v80, v22
    v_mul_f32 v81, v81, v22
    v_mul_f32 v82, v82, v22
    v_mul_f32 v83, v83, v22
    v_mul_f32 v84, v84, v22
    v_mul_f32 v85, v85, v22
    v_mul_f32 v86, v86, v22
    v_mfma_f32_16x16x32_bf16 v[108:111], a[44:47], a[88:91], v[108:111]
    v_mul_f32 v87, v87, v22
    v_cvt_pk_bf16_f32 v80, v80, v81
    v_cvt_pk_bf16_f32 v81, v82, v83
    v_cvt_pk_bf16_f32 v82, v84, v85
    v_cvt_pk_bf16_f32 v83, v86, v87
    s_nop 0
    v_permlane16_swap_b32 v80, v82
    v_mfma_f32_16x16x32_bf16 v[96:99], a[48:51], a[92:95], v[96:99]
    v_permlane16_swap_b32 v81, v83
    s_nop 0
    buffer_store_dwordx4 v[80:83], v18, s[24:27], s52 offen offset:0 nt
    v_mul_f32 v88, v88, v22
    v_mul_f32 v89, v89, v22
    v_mul_f32 v90, v90, v22
    v_mfma_f32_16x16x32_bf16 v[100:103], a[52:55], a[92:95], v[100:103]
    v_mul_f32 v91, v91, v22
    v_mul_f32 v92, v92, v22
    v_mul_f32 v93, v93, v22
    v_mul_f32 v94, v94, v22
    v_mul_f32 v95, v95, v22
    v_cvt_pk_bf16_f32 v88, v88, v89
    v_mfma_f32_16x16x32_bf16 v[104:107], a[56:59], a[92:95], v[104:107]
    v_cvt_pk_bf16_f32 v89, v90, v91
    v_cvt_pk_bf16_f32 v90, v92, v93
    v_cvt_pk_bf16_f32 v91, v94, v95
    s_nop 0
    v_permlane16_swap_b32 v88, v90
    v_permlane16_swap_b32 v89, v91
    s_nop 0
    v_mfma_f32_16x16x32_bf16 v[108:111], a[60:63], a[92:95], v[108:111]
    buffer_store_dwordx4 v[88:91], v18, s[24:27], s52 offen offset:64 nt
    v_mul_f32 v96, v96, v23
    v_mul_f32 v97, v97, v23
    v_mul_f32 v98, v98, v23
    v_mul_f32 v99, v99, v23
    v_mul_f32 v100, v100, v23
    v_mul_f32 v101, v101, v23
    v_mul_f32 v102, v102, v23
    v_mul_f32 v103, v103, v23
    v_cvt_pk_bf16_f32 v96, v96, v97
    v_cvt_pk_bf16_f32 v97, v98, v99
    v_cvt_pk_bf16_f32 v98, v100, v101
    v_cvt_pk_bf16_f32 v99, v102, v103
    s_nop 0
    v_permlane16_swap_b32 v96, v98
    v_permlane16_swap_b32 v97, v99
    s_nop 0
    buffer_store_dwordx4 v[96:99], v18, s[24:27], s53 offen offset:0 nt
    v_mul_f32 v104, v104, v23
    v_mul_f32 v105, v105, v23
    v_mul_f32 v106, v106, v23
    v_mul_f32 v107, v107, v23
    v_mul_f32 v108, v108, v23
    v_mul_f32 v109, v109, v23
    v_mul_f32 v110, v110, v23
    v_mul_f32 v111, v111, v23
    v_cvt_pk_bf16_f32 v104, v104, v105
    v_cvt_pk_bf16_f32 v105, v106, v107
    v_cvt_pk_bf16_f32 v106, v108, v109
    v_cvt_pk_bf16_f32 v107, v110, v111
    s_nop 0
    v_permlane16_swap_b32 v104, v106
    v_permlane16_swap_b32 v105, v107
    s_nop 0
    buffer_store_dwordx4 v[104:107], v18, s[24:27], s53 offen offset:64 nt
    s_branch L_end
L_end:
    s_endpgm
L_slowca3:
    v_and_b32 v12, 0xffff, v11
    v_cmp_ne_u32 vcc, s39, v12
    s_cbranch_vccz L_slowca3_ready
    s_sleep 1
    ds_read_b32 v11, v9 offset:32
    s_waitcnt lgkmcnt(0)
    v_cmp_ne_u32 vcc, s39, v11
    s_cbranch_vccz L_retca3
    s_branch L_slowca3
L_slowca3_ready:
    s_waitcnt lgkmcnt(0)
    s_nop 11
    v_mbcnt_lo_u32_b32 v11, -1, 0
    v_mbcnt_hi_u32_b32 v11, -1, v11
    v_and_b32 v11, 15, v11
    v_lshlrev_b32 v11, 4, v11
    v_add_u32 v11, 151552, v11
    s_lshl_b32 s40, s30, 2
    v_add_u32 v3, s40, v11
    v_mbcnt_lo_u32_b32 v12, -1, 0
    v_mbcnt_hi_u32_b32 v12, -1, v12
    v_lshlrev_b32 v12, 2, v12
    s_mul_i32 s40, s30, 1280
    s_add_u32 s40, s40, 155648
    v_add_u32 v12, s40, v12
    ds_read_b128 v[28:31], v11 offset:1280
    ds_read_b32 v2, v3 offset:1280
    ds_read_b64 v[0:1], v8 offset:10240
    ds_read_b32 v23, v12 offset:0
    s_waitcnt lgkmcnt(3)
    v_max3_f32 v28, v28, v29, v30
    v_max3_f32 v28, v28, v31, v13
    s_waitcnt lgkmcnt(2)
    v_max_f32 v2, v2, v13
    v_sub_f32 v29, v13, v28
    v_sub_f32 v30, v2, v28
    v_exp_f32 v29, v29
    v_exp_f32 v30, v30
    v_mov_b32 v13, v28
    v_mul_f32 v18, v18, v29
    s_waitcnt lgkmcnt(0)
    v_fma_f32 v18, v23, v30, v18
    v_lshlrev_b32 v32, 16, v0
    v_and_b32 v33, 0xffff0000, v0
    v_lshlrev_b32 v34, 16, v1
    v_and_b32 v35, 0xffff0000, v1
    v_mul_f32 v32, v32, v30
    v_mul_f32 v33, v33, v30
    v_mul_f32 v34, v34, v30
    v_mul_f32 v35, v35, v30
    v_cvt_pk_bf16_f32 v0, v32, v33
    v_cvt_pk_bf16_f32 v1, v34, v35
    ds_write_b64 v8, v[0:1] offset:10240
    s_waitcnt lgkmcnt(0)
    ds_read_b128 v[28:31], v11 offset:1536
    ds_read_b32 v2, v3 offset:1536
    ds_read_b64 v[0:1], v8 offset:12288
    ds_read_b32 v24, v12 offset:256
    s_waitcnt lgkmcnt(3)
    v_max3_f32 v28, v28, v29, v30
    v_max3_f32 v28, v28, v31, v14
    s_waitcnt lgkmcnt(2)
    v_max_f32 v2, v2, v14
    v_sub_f32 v29, v14, v28
    v_sub_f32 v30, v2, v28
    v_exp_f32 v29, v29
    v_exp_f32 v30, v30
    v_mov_b32 v14, v28
    v_mul_f32 v19, v19, v29
    s_waitcnt lgkmcnt(0)
    v_fma_f32 v19, v24, v30, v19
    v_lshlrev_b32 v32, 16, v0
    v_and_b32 v33, 0xffff0000, v0
    v_lshlrev_b32 v34, 16, v1
    v_and_b32 v35, 0xffff0000, v1
    v_mul_f32 v32, v32, v30
    v_mul_f32 v33, v33, v30
    v_mul_f32 v34, v34, v30
    v_mul_f32 v35, v35, v30
    v_cvt_pk_bf16_f32 v0, v32, v33
    v_cvt_pk_bf16_f32 v1, v34, v35
    ds_write_b64 v8, v[0:1] offset:12288
    s_waitcnt lgkmcnt(0)
    ds_read_b128 v[28:31], v11 offset:1792
    ds_read_b32 v2, v3 offset:1792
    ds_read_b64 v[0:1], v8 offset:14336
    ds_read_b32 v25, v12 offset:512
    s_waitcnt lgkmcnt(3)
    v_max3_f32 v28, v28, v29, v30
    v_max3_f32 v28, v28, v31, v15
    s_waitcnt lgkmcnt(2)
    v_max_f32 v2, v2, v15
    v_sub_f32 v29, v15, v28
    v_sub_f32 v30, v2, v28
    v_exp_f32 v29, v29
    v_exp_f32 v30, v30
    v_mov_b32 v15, v28
    v_mul_f32 v20, v20, v29
    s_waitcnt lgkmcnt(0)
    v_fma_f32 v20, v25, v30, v20
    v_lshlrev_b32 v32, 16, v0
    v_and_b32 v33, 0xffff0000, v0
    v_lshlrev_b32 v34, 16, v1
    v_and_b32 v35, 0xffff0000, v1
    v_mul_f32 v32, v32, v30
    v_mul_f32 v33, v33, v30
    v_mul_f32 v34, v34, v30
    v_mul_f32 v35, v35, v30
    v_cvt_pk_bf16_f32 v0, v32, v33
    v_cvt_pk_bf16_f32 v1, v34, v35
    ds_write_b64 v8, v[0:1] offset:14336
    s_waitcnt lgkmcnt(0)
    ds_read_b128 v[28:31], v11 offset:2048
    ds_read_b32 v2, v3 offset:2048
    ds_read_b64 v[0:1], v8 offset:16384
    ds_read_b32 v26, v12 offset:768
    s_waitcnt lgkmcnt(3)
    v_max3_f32 v28, v28, v29, v30
    v_max3_f32 v28, v28, v31, v16
    s_waitcnt lgkmcnt(2)
    v_max_f32 v2, v2, v16
    v_sub_f32 v29, v16, v28
    v_sub_f32 v30, v2, v28
    v_exp_f32 v29, v29
    v_exp_f32 v30, v30
    v_mov_b32 v16, v28
    v_mul_f32 v21, v21, v29
    s_waitcnt lgkmcnt(0)
    v_fma_f32 v21, v26, v30, v21
    v_lshlrev_b32 v32, 16, v0
    v_and_b32 v33, 0xffff0000, v0
    v_lshlrev_b32 v34, 16, v1
    v_and_b32 v35, 0xffff0000, v1
    v_mul_f32 v32, v32, v30
    v_mul_f32 v33, v33, v30
    v_mul_f32 v34, v34, v30
    v_mul_f32 v35, v35, v30
    v_cvt_pk_bf16_f32 v0, v32, v33
    v_cvt_pk_bf16_f32 v1, v34, v35
    ds_write_b64 v8, v[0:1] offset:16384
    s_waitcnt lgkmcnt(0)
    ds_read_b128 v[28:31], v11 offset:2304
    ds_read_b32 v2, v3 offset:2304
    ds_read_b64 v[0:1], v8 offset:18432
    ds_read_b32 v27, v12 offset:1024
    s_waitcnt lgkmcnt(3)
    v_max3_f32 v28, v28, v29, v30
    v_max3_f32 v28, v28, v31, v17
    s_waitcnt lgkmcnt(2)
    v_max_f32 v2, v2, v17
    v_sub_f32 v29, v17, v28
    v_sub_f32 v30, v2, v28
    v_exp_f32 v29, v29
    v_exp_f32 v30, v30
    v_mov_b32 v17, v28
    v_mul_f32 v22, v22, v29
    s_waitcnt lgkmcnt(0)
    v_fma_f32 v22, v27, v30, v22
    v_lshlrev_b32 v32, 16, v0
    v_and_b32 v33, 0xffff0000, v0
    v_lshlrev_b32 v34, 16, v1
    v_and_b32 v35, 0xffff0000, v1
    v_mul_f32 v32, v32, v30
    v_mul_f32 v33, v33, v30
    v_mul_f32 v34, v34, v30
    v_mul_f32 v35, v35, v30
    v_cvt_pk_bf16_f32 v0, v32, v33
    v_cvt_pk_bf16_f32 v1, v34, v35
    ds_write_b64 v8, v[0:1] offset:18432
    s_waitcnt lgkmcnt(0)
    s_barrier
    v_mov_b32 v28, 0xff800000
    v_mov_b32 v29, 0
    ds_write_b32 v3, v28 offset:1280
    ds_write_b32 v12, v29 offset:0
    ds_write_b32 v3, v28 offset:1536
    ds_write_b32 v12, v29 offset:256
    ds_write_b32 v3, v28 offset:1792
    ds_write_b32 v12, v29 offset:512
    ds_write_b32 v3, v28 offset:2048
    ds_write_b32 v12, v29 offset:768
    ds_write_b32 v3, v28 offset:2304
    ds_write_b32 v12, v29 offset:1024
    s_waitcnt lgkmcnt(0)
    v_fma_f32 v28, v40, s32, -v13
    v_fma_f32 v29, v41, s32, -v13
    v_fma_f32 v30, v42, s32, -v13
    v_fma_f32 v31, v43, s32, -v13
    v_exp_f32 v28, v28
    v_exp_f32 v29, v29
    v_exp_f32 v30, v30
    v_exp_f32 v31, v31
    v_cvt_pk_bf16_f32 v0, v28, v29
    v_add_f32 v23, v28, v29
    v_cvt_pk_bf16_f32 v1, v30, v31
    v_add_f32 v30, v30, v31
    v_add_f32 v23, v23, v30
    v_fma_f32 v32, v48, s32, -v14
    v_fma_f32 v33, v49, s32, -v14
    v_fma_f32 v34, v50, s32, -v14
    v_fma_f32 v35, v51, s32, -v14
    v_exp_f32 v32, v32
    v_exp_f32 v33, v33
    v_exp_f32 v34, v34
    v_exp_f32 v35, v35
    v_cvt_pk_bf16_f32 v2, v32, v33
    v_add_f32 v24, v32, v33
    v_cvt_pk_bf16_f32 v3, v34, v35
    v_add_f32 v34, v34, v35
    v_add_f32 v24, v24, v34
    v_fma_f32 v28, v52, s32, -v15
    v_fma_f32 v29, v53, s32, -v15
    v_fma_f32 v30, v54, s32, -v15
    v_fma_f32 v31, v55, s32, -v15
    v_exp_f32 v28, v28
    v_exp_f32 v29, v29
    v_exp_f32 v30, v30
    v_exp_f32 v31, v31
    v_cvt_pk_bf16_f32 v36, v28, v29
    v_add_f32 v25, v28, v29
    v_cvt_pk_bf16_f32 v37, v30, v31
    v_add_f32 v30, v30, v31
    v_add_f32 v25, v25, v30
    v_fma_f32 v32, v56, s32, -v16
    v_fma_f32 v33, v57, s32, -v16
    v_fma_f32 v34, v58, s32, -v16
    v_fma_f32 v35, v59, s32, -v16
    v_exp_f32 v32, v32
    v_exp_f32 v33, v33
    v_exp_f32 v34, v34
    v_exp_f32 v35, v35
    v_cvt_pk_bf16_f32 v38, v32, v33
    v_add_f32 v26, v32, v33
    v_cvt_pk_bf16_f32 v39, v34, v35
    v_add_f32 v34, v34, v35
    v_add_f32 v26, v26, v34
    v_fma_f32 v28, v60, s32, -v17
    v_fma_f32 v29, v61, s32, -v17
    v_fma_f32 v30, v62, s32, -v17
    v_fma_f32 v31, v63, s32, -v17
    v_exp_f32 v28, v28
    v_exp_f32 v29, v29
    v_exp_f32 v30, v30
    v_exp_f32 v31, v31
    v_cvt_pk_bf16_f32 v34, v28, v29
    v_add_f32 v27, v28, v29
    v_cvt_pk_bf16_f32 v35, v30, v31
    v_add_f32 v30, v30, v31
    v_add_f32 v27, v27, v30
    s_nop 3
    s_branch L_retca3
L_slowp3:
    s_waitcnt lgkmcnt(0)
    s_nop 11
    v_mbcnt_lo_u32_b32 v11, -1, 0
    v_mbcnt_hi_u32_b32 v11, -1, v11
    v_and_b32 v11, 15, v11
    v_lshlrev_b32 v11, 4, v11
    v_add_u32 v11, 151552, v11
    s_lshl_b32 s40, s30, 2
    v_add_u32 v11, s40, v11
    v_max3_f32 v32, v40, v41, v42
    v_max_f32 v32, v32, v43
    v_mov_b32 v33, v32
    s_nop 1
    v_permlane16_swap_b32 v32, v33
    s_nop 0
    v_max_f32 v32, v32, v33
    v_mov_b32 v33, v32
    s_nop 1
    v_permlane32_swap_b32 v32, v33
    s_nop 0
    v_max_f32 v32, v32, v33
    v_mul_f32 v32, s32, v32
    v_ceil_f32 v32, v32
    v_max_f32 v32, v32, v13
    ds_write_b32 v11, v32 offset:0
    v_fma_f32 v28, v40, s32, -v32
    v_fma_f32 v29, v41, s32, -v32
    v_fma_f32 v30, v42, s32, -v32
    v_fma_f32 v31, v43, s32, -v32
    v_exp_f32 v28, v28
    v_exp_f32 v29, v29
    v_exp_f32 v30, v30
    v_exp_f32 v31, v31
    v_cvt_pk_bf16_f32 v0, v28, v29
    v_add_f32 v23, v28, v29
    v_cvt_pk_bf16_f32 v1, v30, v31
    v_add_f32 v30, v30, v31
    v_add_f32 v23, v23, v30
    s_waitcnt lgkmcnt(0)
    v_max3_f32 v28, v48, v49, v50
    v_max_f32 v28, v28, v51
    v_mov_b32 v29, v28
    s_nop 1
    v_permlane16_swap_b32 v28, v29
    s_nop 0
    v_max_f32 v28, v28, v29
    v_mov_b32 v29, v28
    s_nop 1
    v_permlane32_swap_b32 v28, v29
    s_nop 0
    v_max_f32 v28, v28, v29
    v_mul_f32 v28, s32, v28
    v_ceil_f32 v28, v28
    v_max_f32 v28, v28, v14
    ds_write_b32 v11, v28 offset:256
    v_fma_f32 v32, v48, s32, -v28
    v_fma_f32 v33, v49, s32, -v28
    v_fma_f32 v34, v50, s32, -v28
    v_fma_f32 v35, v51, s32, -v28
    v_exp_f32 v32, v32
    v_exp_f32 v33, v33
    v_exp_f32 v34, v34
    v_exp_f32 v35, v35
    v_cvt_pk_bf16_f32 v2, v32, v33
    v_add_f32 v24, v32, v33
    v_cvt_pk_bf16_f32 v3, v34, v35
    v_add_f32 v34, v34, v35
    v_add_f32 v24, v24, v34
    s_waitcnt lgkmcnt(0)
    v_max3_f32 v32, v52, v53, v54
    v_max_f32 v32, v32, v55
    v_mov_b32 v33, v32
    s_nop 1
    v_permlane16_swap_b32 v32, v33
    s_nop 0
    v_max_f32 v32, v32, v33
    v_mov_b32 v33, v32
    s_nop 1
    v_permlane32_swap_b32 v32, v33
    s_nop 0
    v_max_f32 v32, v32, v33
    v_mul_f32 v32, s32, v32
    v_ceil_f32 v32, v32
    v_max_f32 v32, v32, v15
    ds_write_b32 v11, v32 offset:512
    v_fma_f32 v28, v52, s32, -v32
    v_fma_f32 v29, v53, s32, -v32
    v_fma_f32 v30, v54, s32, -v32
    v_fma_f32 v31, v55, s32, -v32
    v_exp_f32 v28, v28
    v_exp_f32 v29, v29
    v_exp_f32 v30, v30
    v_exp_f32 v31, v31
    v_cvt_pk_bf16_f32 v36, v28, v29
    v_add_f32 v25, v28, v29
    v_cvt_pk_bf16_f32 v37, v30, v31
    v_add_f32 v30, v30, v31
    v_add_f32 v25, v25, v30
    s_waitcnt lgkmcnt(0)
    v_max3_f32 v28, v56, v57, v58
    v_max_f32 v28, v28, v59
    v_mov_b32 v29, v28
    s_nop 1
    v_permlane16_swap_b32 v28, v29
    s_nop 0
    v_max_f32 v28, v28, v29
    v_mov_b32 v29, v28
    s_nop 1
    v_permlane32_swap_b32 v28, v29
    s_nop 0
    v_max_f32 v28, v28, v29
    v_mul_f32 v28, s32, v28
    v_ceil_f32 v28, v28
    v_max_f32 v28, v28, v16
    ds_write_b32 v11, v28 offset:768
    v_fma_f32 v32, v56, s32, -v28
    v_fma_f32 v33, v57, s32, -v28
    v_fma_f32 v34, v58, s32, -v28
    v_fma_f32 v35, v59, s32, -v28
    v_exp_f32 v32, v32
    v_exp_f32 v33, v33
    v_exp_f32 v34, v34
    v_exp_f32 v35, v35
    v_cvt_pk_bf16_f32 v38, v32, v33
    v_add_f32 v26, v32, v33
    v_cvt_pk_bf16_f32 v39, v34, v35
    v_add_f32 v34, v34, v35
    v_add_f32 v26, v26, v34
    s_waitcnt lgkmcnt(0)
    v_max3_f32 v32, v60, v61, v62
    v_max_f32 v32, v32, v63
    v_mov_b32 v33, v32
    s_nop 1
    v_permlane16_swap_b32 v32, v33
    s_nop 0
    v_max_f32 v32, v32, v33
    v_mov_b32 v33, v32
    s_nop 1
    v_permlane32_swap_b32 v32, v33
    s_nop 0
    v_max_f32 v32, v32, v33
    v_mul_f32 v32, s32, v32
    v_ceil_f32 v32, v32
    v_max_f32 v32, v32, v17
    ds_write_b32 v11, v32 offset:1024
    v_fma_f32 v28, v60, s32, -v32
    v_fma_f32 v29, v61, s32, -v32
    v_fma_f32 v30, v62, s32, -v32
    v_fma_f32 v31, v63, s32, -v32
    v_exp_f32 v28, v28
    v_exp_f32 v29, v29
    v_exp_f32 v30, v30
    v_exp_f32 v31, v31
    v_cvt_pk_bf16_f32 v34, v28, v29
    v_add_f32 v27, v28, v29
    v_cvt_pk_bf16_f32 v35, v30, v31
    v_add_f32 v30, v30, v31
    v_add_f32 v27, v27, v30
    s_waitcnt lgkmcnt(0)
    v_mbcnt_lo_u32_b32 v11, -1, 0
    v_mbcnt_hi_u32_b32 v11, -1, v11
    v_lshlrev_b32 v11, 2, v11
    s_mul_i32 s40, s30, 1280
    s_add_u32 s40, s40, 155648
    v_add_u32 v11, s40, v11
    ds_write_b32 v11, v23 offset:0
    v_mov_b32 v23, 0
    ds_write_b32 v11, v24 offset:256
    v_mov_b32 v24, 0
    ds_write_b32 v11, v25 offset:512
    v_mov_b32 v25, 0
    ds_write_b32 v11, v26 offset:768
    v_mov_b32 v26, 0
    ds_write_b32 v11, v27 offset:1024
    v_mov_b32 v27, 0
    s_waitcnt lgkmcnt(0)
    v_or_b32 v12, 0x10000, v12
    s_nop 3
    s_branch L_retp3
L_slowca4:
    v_and_b32 v12, 0xffff, v11
    v_cmp_ne_u32 vcc, s39, v12
    s_cbranch_vccz L_slowca4_ready
    s_sleep 1
    ds_read_b32 v11, v9 offset:0
    s_waitcnt lgkmcnt(0)
    v_cmp_ne_u32 vcc, s39, v11
    s_cbranch_vccz L_retca4
    s_branch L_slowca4
L_slowca4_ready:
    s_waitcnt lgkmcnt(0)
    s_nop 11
    v_mbcnt_lo_u32_b32 v11, -1, 0
    v_mbcnt_hi_u32_b32 v11, -1, v11
    v_and_b32 v11, 15, v11
    v_lshlrev_b32 v11, 4, v11
    v_add_u32 v11, 151552, v11
    s_lshl_b32 s40, s30, 2
    v_add_u32 v3, s40, v11
    v_mbcnt_lo_u32_b32 v12, -1, 0
    v_mbcnt_hi_u32_b32 v12, -1, v12
    v_lshlrev_b32 v12, 2, v12
    s_mul_i32 s40, s30, 1280
    s_add_u32 s40, s40, 155648
    v_add_u32 v12, s40, v12
    ds_read_b128 v[28:31], v11 offset:0
    ds_read_b32 v2, v3 offset:0
    ds_read_b64 v[0:1], v8 offset:0
    ds_read_b32 v23, v12 offset:0
    s_waitcnt lgkmcnt(3)
    v_max3_f32 v28, v28, v29, v30
    v_max3_f32 v28, v28, v31, v13
    s_waitcnt lgkmcnt(2)
    v_max_f32 v2, v2, v13
    v_sub_f32 v29, v13, v28
    v_sub_f32 v30, v2, v28
    v_exp_f32 v29, v29
    v_exp_f32 v30, v30
    v_mov_b32 v13, v28
    v_mul_f32 v18, v18, v29
    s_waitcnt lgkmcnt(0)
    v_fma_f32 v18, v23, v30, v18
    v_lshlrev_b32 v32, 16, v0
    v_and_b32 v33, 0xffff0000, v0
    v_lshlrev_b32 v34, 16, v1
    v_and_b32 v35, 0xffff0000, v1
    v_mul_f32 v32, v32, v30
    v_mul_f32 v33, v33, v30
    v_mul_f32 v34, v34, v30
    v_mul_f32 v35, v35, v30
    v_cvt_pk_bf16_f32 v0, v32, v33
    v_cvt_pk_bf16_f32 v1, v34, v35
    ds_write_b64 v8, v[0:1] offset:0
    s_waitcnt lgkmcnt(0)
    ds_read_b128 v[28:31], v11 offset:256
    ds_read_b32 v2, v3 offset:256
    ds_read_b64 v[0:1], v8 offset:2048
    ds_read_b32 v24, v12 offset:256
    s_waitcnt lgkmcnt(3)
    v_max3_f32 v28, v28, v29, v30
    v_max3_f32 v28, v28, v31, v14
    s_waitcnt lgkmcnt(2)
    v_max_f32 v2, v2, v14
    v_sub_f32 v29, v14, v28
    v_sub_f32 v30, v2, v28
    v_exp_f32 v29, v29
    v_exp_f32 v30, v30
    v_mov_b32 v14, v28
    v_mul_f32 v19, v19, v29
    s_waitcnt lgkmcnt(0)
    v_fma_f32 v19, v24, v30, v19
    v_lshlrev_b32 v32, 16, v0
    v_and_b32 v33, 0xffff0000, v0
    v_lshlrev_b32 v34, 16, v1
    v_and_b32 v35, 0xffff0000, v1
    v_mul_f32 v32, v32, v30
    v_mul_f32 v33, v33, v30
    v_mul_f32 v34, v34, v30
    v_mul_f32 v35, v35, v30
    v_cvt_pk_bf16_f32 v0, v32, v33
    v_cvt_pk_bf16_f32 v1, v34, v35
    ds_write_b64 v8, v[0:1] offset:2048
    s_waitcnt lgkmcnt(0)
    ds_read_b128 v[28:31], v11 offset:512
    ds_read_b32 v2, v3 offset:512
    ds_read_b64 v[0:1], v8 offset:4096
    ds_read_b32 v25, v12 offset:512
    s_waitcnt lgkmcnt(3)
    v_max3_f32 v28, v28, v29, v30
    v_max3_f32 v28, v28, v31, v15
    s_waitcnt lgkmcnt(2)
    v_max_f32 v2, v2, v15
    v_sub_f32 v29, v15, v28
    v_sub_f32 v30, v2, v28
    v_exp_f32 v29, v29
    v_exp_f32 v30, v30
    v_mov_b32 v15, v28
    v_mul_f32 v20, v20, v29
    s_waitcnt lgkmcnt(0)
    v_fma_f32 v20, v25, v30, v20
    v_lshlrev_b32 v32, 16, v0
    v_and_b32 v33, 0xffff0000, v0
    v_lshlrev_b32 v34, 16, v1
    v_and_b32 v35, 0xffff0000, v1
    v_mul_f32 v32, v32, v30
    v_mul_f32 v33, v33, v30
    v_mul_f32 v34, v34, v30
    v_mul_f32 v35, v35, v30
    v_cvt_pk_bf16_f32 v0, v32, v33
    v_cvt_pk_bf16_f32 v1, v34, v35
    ds_write_b64 v8, v[0:1] offset:4096
    s_waitcnt lgkmcnt(0)
    ds_read_b128 v[28:31], v11 offset:768
    ds_read_b32 v2, v3 offset:768
    ds_read_b64 v[0:1], v8 offset:6144
    ds_read_b32 v26, v12 offset:768
    s_waitcnt lgkmcnt(3)
    v_max3_f32 v28, v28, v29, v30
    v_max3_f32 v28, v28, v31, v16
    s_waitcnt lgkmcnt(2)
    v_max_f32 v2, v2, v16
    v_sub_f32 v29, v16, v28
    v_sub_f32 v30, v2, v28
    v_exp_f32 v29, v29
    v_exp_f32 v30, v30
    v_mov_b32 v16, v28
    v_mul_f32 v21, v21, v29
    s_waitcnt lgkmcnt(0)
    v_fma_f32 v21, v26, v30, v21
    v_lshlrev_b32 v32, 16, v0
    v_and_b32 v33, 0xffff0000, v0
    v_lshlrev_b32 v34, 16, v1
    v_and_b32 v35, 0xffff0000, v1
    v_mul_f32 v32, v32, v30
    v_mul_f32 v33, v33, v30
    v_mul_f32 v34, v34, v30
    v_mul_f32 v35, v35, v30
    v_cvt_pk_bf16_f32 v0, v32, v33
    v_cvt_pk_bf16_f32 v1, v34, v35
    ds_write_b64 v8, v[0:1] offset:6144
    s_waitcnt lgkmcnt(0)
    ds_read_b128 v[28:31], v11 offset:1024
    ds_read_b32 v2, v3 offset:1024
    ds_read_b64 v[0:1], v8 offset:8192
    ds_read_b32 v27, v12 offset:1024
    s_waitcnt lgkmcnt(3)
    v_max3_f32 v28, v28, v29, v30
    v_max3_f32 v28, v28, v31, v17
    s_waitcnt lgkmcnt(2)
    v_max_f32 v2, v2, v17
    v_sub_f32 v29, v17, v28
    v_sub_f32 v30, v2, v28
    v_exp_f32 v29, v29
    v_exp_f32 v30, v30
    v_mov_b32 v17, v28
    v_mul_f32 v22, v22, v29
    s_waitcnt lgkmcnt(0)
    v_fma_f32 v22, v27, v30, v22
    v_lshlrev_b32 v32, 16, v0
    v_and_b32 v33, 0xffff0000, v0
    v_lshlrev_b32 v34, 16, v1
    v_and_b32 v35, 0xffff0000, v1
    v_mul_f32 v32, v32, v30
    v_mul_f32 v33, v33, v30
    v_mul_f32 v34, v34, v30
    v_mul_f32 v35, v35, v30
    v_cvt_pk_bf16_f32 v0, v32, v33
    v_cvt_pk_bf16_f32 v1, v34, v35
    ds_write_b64 v8, v[0:1] offset:8192
    s_waitcnt lgkmcnt(0)
    s_barrier
    v_mov_b32 v28, 0xff800000
    v_mov_b32 v29, 0
    ds_write_b32 v3, v28 offset:0
    ds_write_b32 v12, v29 offset:0
    ds_write_b32 v3, v28 offset:256
    ds_write_b32 v12, v29 offset:256
    ds_write_b32 v3, v28 offset:512
    ds_write_b32 v12, v29 offset:512
    ds_write_b32 v3, v28 offset:768
    ds_write_b32 v12, v29 offset:768
    ds_write_b32 v3, v28 offset:1024
    ds_write_b32 v12, v29 offset:1024
    s_waitcnt lgkmcnt(0)
    v_fma_f32 v28, v44, s32, -v13
    v_fma_f32 v29, v45, s32, -v13
    v_fma_f32 v30, v46, s32, -v13
    v_fma_f32 v31, v47, s32, -v13
    v_exp_f32 v28, v28
    v_exp_f32 v29, v29
    v_exp_f32 v30, v30
    v_exp_f32 v31, v31
    v_cvt_pk_bf16_f32 v0, v28, v29
    v_add_f32 v23, v28, v29
    v_cvt_pk_bf16_f32 v1, v30, v31
    v_add_f32 v30, v30, v31
    v_add_f32 v23, v23, v30
    v_fma_f32 v32, v48, s32, -v14
    v_fma_f32 v33, v49, s32, -v14
    v_fma_f32 v34, v50, s32, -v14
    v_fma_f32 v35, v51, s32, -v14
    v_exp_f32 v32, v32
    v_exp_f32 v33, v33
    v_exp_f32 v34, v34
    v_exp_f32 v35, v35
    v_cvt_pk_bf16_f32 v2, v32, v33
    v_add_f32 v24, v32, v33
    v_cvt_pk_bf16_f32 v3, v34, v35
    v_add_f32 v34, v34, v35
    v_add_f32 v24, v24, v34
    v_fma_f32 v28, v52, s32, -v15
    v_fma_f32 v29, v53, s32, -v15
    v_fma_f32 v30, v54, s32, -v15
    v_fma_f32 v31, v55, s32, -v15
    v_exp_f32 v28, v28
    v_exp_f32 v29, v29
    v_exp_f32 v30, v30
    v_exp_f32 v31, v31
    v_cvt_pk_bf16_f32 v36, v28, v29
    v_add_f32 v25, v28, v29
    v_cvt_pk_bf16_f32 v37, v30, v31
    v_add_f32 v30, v30, v31
    v_add_f32 v25, v25, v30
    v_fma_f32 v32, v56, s32, -v16
    v_fma_f32 v33, v57, s32, -v16
    v_fma_f32 v34, v58, s32, -v16
    v_fma_f32 v35, v59, s32, -v16
    v_exp_f32 v32, v32
    v_exp_f32 v33, v33
    v_exp_f32 v34, v34
    v_exp_f32 v35, v35
    v_cvt_pk_bf16_f32 v38, v32, v33
    v_add_f32 v26, v32, v33
    v_cvt_pk_bf16_f32 v39, v34, v35
    v_add_f32 v34, v34, v35
    v_add_f32 v26, v26, v34
    v_fma_f32 v28, v60, s32, -v17
    v_fma_f32 v29, v61, s32, -v17
    v_fma_f32 v30, v62, s32, -v17
    v_fma_f32 v31, v63, s32, -v17
    v_exp_f32 v28, v28
    v_exp_f32 v29, v29
    v_exp_f32 v30, v30
    v_exp_f32 v31, v31
    v_cvt_pk_bf16_f32 v34, v28, v29
    v_add_f32 v27, v28, v29
    v_cvt_pk_bf16_f32 v35, v30, v31
    v_add_f32 v30, v30, v31
    v_add_f32 v27, v27, v30
    s_nop 3
    s_branch L_retca4
L_slowp4:
    s_waitcnt lgkmcnt(0)
    s_nop 11
    v_mbcnt_lo_u32_b32 v11, -1, 0
    v_mbcnt_hi_u32_b32 v11, -1, v11
    v_and_b32 v11, 15, v11
    v_lshlrev_b32 v11, 4, v11
    v_add_u32 v11, 151552, v11
    s_lshl_b32 s40, s30, 2
    v_add_u32 v11, s40, v11
    v_max3_f32 v32, v44, v45, v46
    v_max_f32 v32, v32, v47
    v_mov_b32 v33, v32
    s_nop 1
    v_permlane16_swap_b32 v32, v33
    s_nop 0
    v_max_f32 v32, v32, v33
    v_mov_b32 v33, v32
    s_nop 1
    v_permlane32_swap_b32 v32, v33
    s_nop 0
    v_max_f32 v32, v32, v33
    v_mul_f32 v32, s32, v32
    v_ceil_f32 v32, v32
    v_max_f32 v32, v32, v13
    ds_write_b32 v11, v32 offset:1280
    v_fma_f32 v28, v44, s32, -v32
    v_fma_f32 v29, v45, s32, -v32
    v_fma_f32 v30, v46, s32, -v32
    v_fma_f32 v31, v47, s32, -v32
    v_exp_f32 v28, v28
    v_exp_f32 v29, v29
    v_exp_f32 v30, v30
    v_exp_f32 v31, v31
    v_cvt_pk_bf16_f32 v0, v28, v29
    v_add_f32 v23, v28, v29
    v_cvt_pk_bf16_f32 v1, v30, v31
    v_add_f32 v30, v30, v31
    v_add_f32 v23, v23, v30
    s_waitcnt lgkmcnt(0)
    v_max3_f32 v28, v48, v49, v50
    v_max_f32 v28, v28, v51
    v_mov_b32 v29, v28
    s_nop 1
    v_permlane16_swap_b32 v28, v29
    s_nop 0
    v_max_f32 v28, v28, v29
    v_mov_b32 v29, v28
    s_nop 1
    v_permlane32_swap_b32 v28, v29
    s_nop 0
    v_max_f32 v28, v28, v29
    v_mul_f32 v28, s32, v28
    v_ceil_f32 v28, v28
    v_max_f32 v28, v28, v14
    ds_write_b32 v11, v28 offset:1536
    v_fma_f32 v32, v48, s32, -v28
    v_fma_f32 v33, v49, s32, -v28
    v_fma_f32 v34, v50, s32, -v28
    v_fma_f32 v35, v51, s32, -v28
    v_exp_f32 v32, v32
    v_exp_f32 v33, v33
    v_exp_f32 v34, v34
    v_exp_f32 v35, v35
    v_cvt_pk_bf16_f32 v2, v32, v33
    v_add_f32 v24, v32, v33
    v_cvt_pk_bf16_f32 v3, v34, v35
    v_add_f32 v34, v34, v35
    v_add_f32 v24, v24, v34
    s_waitcnt lgkmcnt(0)
    v_max3_f32 v32, v52, v53, v54
    v_max_f32 v32, v32, v55
    v_mov_b32 v33, v32
    s_nop 1
    v_permlane16_swap_b32 v32, v33
    s_nop 0
    v_max_f32 v32, v32, v33
    v_mov_b32 v33, v32
    s_nop 1
    v_permlane32_swap_b32 v32, v33
    s_nop 0
    v_max_f32 v32, v32, v33
    v_mul_f32 v32, s32, v32
    v_ceil_f32 v32, v32
    v_max_f32 v32, v32, v15
    ds_write_b32 v11, v32 offset:1792
    v_fma_f32 v28, v52, s32, -v32
    v_fma_f32 v29, v53, s32, -v32
    v_fma_f32 v30, v54, s32, -v32
    v_fma_f32 v31, v55, s32, -v32
    v_exp_f32 v28, v28
    v_exp_f32 v29, v29
    v_exp_f32 v30, v30
    v_exp_f32 v31, v31
    v_cvt_pk_bf16_f32 v36, v28, v29
    v_add_f32 v25, v28, v29
    v_cvt_pk_bf16_f32 v37, v30, v31
    v_add_f32 v30, v30, v31
    v_add_f32 v25, v25, v30
    s_waitcnt lgkmcnt(0)
    v_max3_f32 v28, v56, v57, v58
    v_max_f32 v28, v28, v59
    v_mov_b32 v29, v28
    s_nop 1
    v_permlane16_swap_b32 v28, v29
    s_nop 0
    v_max_f32 v28, v28, v29
    v_mov_b32 v29, v28
    s_nop 1
    v_permlane32_swap_b32 v28, v29
    s_nop 0
    v_max_f32 v28, v28, v29
    v_mul_f32 v28, s32, v28
    v_ceil_f32 v28, v28
    v_max_f32 v28, v28, v16
    ds_write_b32 v11, v28 offset:2048
    v_fma_f32 v32, v56, s32, -v28
    v_fma_f32 v33, v57, s32, -v28
    v_fma_f32 v34, v58, s32, -v28
    v_fma_f32 v35, v59, s32, -v28
    v_exp_f32 v32, v32
    v_exp_f32 v33, v33
    v_exp_f32 v34, v34
    v_exp_f32 v35, v35
    v_cvt_pk_bf16_f32 v38, v32, v33
    v_add_f32 v26, v32, v33
    v_cvt_pk_bf16_f32 v39, v34, v35
    v_add_f32 v34, v34, v35
    v_add_f32 v26, v26, v34
    s_waitcnt lgkmcnt(0)
    v_max3_f32 v32, v60, v61, v62
    v_max_f32 v32, v32, v63
    v_mov_b32 v33, v32
    s_nop 1
    v_permlane16_swap_b32 v32, v33
    s_nop 0
    v_max_f32 v32, v32, v33
    v_mov_b32 v33, v32
    s_nop 1
    v_permlane32_swap_b32 v32, v33
    s_nop 0
    v_max_f32 v32, v32, v33
    v_mul_f32 v32, s32, v32
    v_ceil_f32 v32, v32
    v_max_f32 v32, v32, v17
    ds_write_b32 v11, v32 offset:2304
    v_fma_f32 v28, v60, s32, -v32
    v_fma_f32 v29, v61, s32, -v32
    v_fma_f32 v30, v62, s32, -v32
    v_fma_f32 v31, v63, s32, -v32
    v_exp_f32 v28, v28
    v_exp_f32 v29, v29
    v_exp_f32 v30, v30
    v_exp_f32 v31, v31
    v_cvt_pk_bf16_f32 v34, v28, v29
    v_add_f32 v27, v28, v29
    v_cvt_pk_bf16_f32 v35, v30, v31
    v_add_f32 v30, v30, v31
    v_add_f32 v27, v27, v30
    s_waitcnt lgkmcnt(0)
    v_mbcnt_lo_u32_b32 v11, -1, 0
    v_mbcnt_hi_u32_b32 v11, -1, v11
    v_lshlrev_b32 v11, 2, v11
    s_mul_i32 s40, s30, 1280
    s_add_u32 s40, s40, 155648
    v_add_u32 v11, s40, v11
    ds_write_b32 v11, v23 offset:0
    v_mov_b32 v23, 0
    ds_write_b32 v11, v24 offset:256
    v_mov_b32 v24, 0
    ds_write_b32 v11, v25 offset:512
    v_mov_b32 v25, 0
    ds_write_b32 v11, v26 offset:768
    v_mov_b32 v26, 0
    ds_write_b32 v11, v27 offset:1024
    v_mov_b32 v27, 0
    s_waitcnt lgkmcnt(0)
    v_or_b32 v12, 0x10000, v12
    s_nop 3
    s_branch L_retp4
L_slowca5:
    v_and_b32 v12, 0xffff, v11
    v_cmp_ne_u32 vcc, s39, v12
    s_cbranch_vccz L_slowca5_ready
    s_sleep 1
    ds_read_b32 v11, v9 offset:0
    s_waitcnt lgkmcnt(0)
    v_cmp_ne_u32 vcc, s39, v11
    s_cbranch_vccz L_retca5
    s_branch L_slowca5
L_slowca5_ready:
    s_waitcnt lgkmcnt(0)
    s_nop 11
    v_mbcnt_lo_u32_b32 v11, -1, 0
    v_mbcnt_hi_u32_b32 v11, -1, v11
    v_and_b32 v11, 15, v11
    v_lshlrev_b32 v11, 4, v11
    v_add_u32 v11, 151552, v11
    s_lshl_b32 s40, s30, 2
    v_add_u32 v3, s40, v11
    v_mbcnt_lo_u32_b32 v12, -1, 0
    v_mbcnt_hi_u32_b32 v12, -1, v12
    v_lshlrev_b32 v12, 2, v12
    s_mul_i32 s40, s30, 1280
    s_add_u32 s40, s40, 155648
    v_add_u32 v12, s40, v12
    ds_read_b128 v[28:31], v11 offset:0
    ds_read_b32 v2, v3 offset:0
    ds_read_b64 v[0:1], v8 offset:0
    ds_read_b32 v23, v12 offset:0
    s_waitcnt lgkmcnt(3)
    v_max3_f32 v28, v28, v29, v30
    v_max3_f32 v28, v28, v31, v13
    s_waitcnt lgkmcnt(2)
    v_max_f32 v2, v2, v13
    v_sub_f32 v29, v13, v28
    v_sub_f32 v30, v2, v28
    v_exp_f32 v29, v29
    v_exp_f32 v30, v30
    v_mov_b32 v13, v28
    v_mul_f32 v18, v18, v29
    s_waitcnt lgkmcnt(0)
    v_fma_f32 v18, v23, v30, v18
    v_lshlrev_b32 v32, 16, v0
    v_and_b32 v33, 0xffff0000, v0
    v_lshlrev_b32 v34, 16, v1
    v_and_b32 v35, 0xffff0000, v1
    v_mul_f32 v32, v32, v30
    v_mul_f32 v33, v33, v30
    v_mul_f32 v34, v34, v30
    v_mul_f32 v35, v35, v30
    v_cvt_pk_bf16_f32 v0, v32, v33
    v_cvt_pk_bf16_f32 v1, v34, v35
    ds_write_b64 v8, v[0:1] offset:0
    s_waitcnt lgkmcnt(0)
    ds_read_b128 v[28:31], v11 offset:256
    ds_read_b32 v2, v3 offset:256
    ds_read_b64 v[0:1], v8 offset:2048
    ds_read_b32 v24, v12 offset:256
    s_waitcnt lgkmcnt(3)
    v_max3_f32 v28, v28, v29, v30
    v_max3_f32 v28, v28, v31, v14
    s_waitcnt lgkmcnt(2)
    v_max_f32 v2, v2, v14
    v_sub_f32 v29, v14, v28
    v_sub_f32 v30, v2, v28
    v_exp_f32 v29, v29
    v_exp_f32 v30, v30
    v_mov_b32 v14, v28
    v_mul_f32 v19, v19, v29
    s_waitcnt lgkmcnt(0)
    v_fma_f32 v19, v24, v30, v19
    v_lshlrev_b32 v32, 16, v0
    v_and_b32 v33, 0xffff0000, v0
    v_lshlrev_b32 v34, 16, v1
    v_and_b32 v35, 0xffff0000, v1
    v_mul_f32 v32, v32, v30
    v_mul_f32 v33, v33, v30
    v_mul_f32 v34, v34, v30
    v_mul_f32 v35, v35, v30
    v_cvt_pk_bf16_f32 v0, v32, v33
    v_cvt_pk_bf16_f32 v1, v34, v35
    ds_write_b64 v8, v[0:1] offset:2048
    s_waitcnt lgkmcnt(0)
    ds_read_b128 v[28:31], v11 offset:512
    ds_read_b32 v2, v3 offset:512
    ds_read_b64 v[0:1], v8 offset:4096
    ds_read_b32 v25, v12 offset:512
    s_waitcnt lgkmcnt(3)
    v_max3_f32 v28, v28, v29, v30
    v_max3_f32 v28, v28, v31, v15
    s_waitcnt lgkmcnt(2)
    v_max_f32 v2, v2, v15
    v_sub_f32 v29, v15, v28
    v_sub_f32 v30, v2, v28
    v_exp_f32 v29, v29
    v_exp_f32 v30, v30
    v_mov_b32 v15, v28
    v_mul_f32 v20, v20, v29
    s_waitcnt lgkmcnt(0)
    v_fma_f32 v20, v25, v30, v20
    v_lshlrev_b32 v32, 16, v0
    v_and_b32 v33, 0xffff0000, v0
    v_lshlrev_b32 v34, 16, v1
    v_and_b32 v35, 0xffff0000, v1
    v_mul_f32 v32, v32, v30
    v_mul_f32 v33, v33, v30
    v_mul_f32 v34, v34, v30
    v_mul_f32 v35, v35, v30
    v_cvt_pk_bf16_f32 v0, v32, v33
    v_cvt_pk_bf16_f32 v1, v34, v35
    ds_write_b64 v8, v[0:1] offset:4096
    s_waitcnt lgkmcnt(0)
    ds_read_b128 v[28:31], v11 offset:768
    ds_read_b32 v2, v3 offset:768
    ds_read_b64 v[0:1], v8 offset:6144
    ds_read_b32 v26, v12 offset:768
    s_waitcnt lgkmcnt(3)
    v_max3_f32 v28, v28, v29, v30
    v_max3_f32 v28, v28, v31, v16
    s_waitcnt lgkmcnt(2)
    v_max_f32 v2, v2, v16
    v_sub_f32 v29, v16, v28
    v_sub_f32 v30, v2, v28
    v_exp_f32 v29, v29
    v_exp_f32 v30, v30
    v_mov_b32 v16, v28
    v_mul_f32 v21, v21, v29
    s_waitcnt lgkmcnt(0)
    v_fma_f32 v21, v26, v30, v21
    v_lshlrev_b32 v32, 16, v0
    v_and_b32 v33, 0xffff0000, v0
    v_lshlrev_b32 v34, 16, v1
    v_and_b32 v35, 0xffff0000, v1
    v_mul_f32 v32, v32, v30
    v_mul_f32 v33, v33, v30
    v_mul_f32 v34, v34, v30
    v_mul_f32 v35, v35, v30
    v_cvt_pk_bf16_f32 v0, v32, v33
    v_cvt_pk_bf16_f32 v1, v34, v35
    ds_write_b64 v8, v[0:1] offset:6144
    s_waitcnt lgkmcnt(0)
    ds_read_b128 v[28:31], v11 offset:1024
    ds_read_b32 v2, v3 offset:1024
    ds_read_b64 v[0:1], v8 offset:8192
    ds_read_b32 v27, v12 offset:1024
    s_waitcnt lgkmcnt(3)
    v_max3_f32 v28, v28, v29, v30
    v_max3_f32 v28, v28, v31, v17
    s_waitcnt lgkmcnt(2)
    v_max_f32 v2, v2, v17
    v_sub_f32 v29, v17, v28
    v_sub_f32 v30, v2, v28
    v_exp_f32 v29, v29
    v_exp_f32 v30, v30
    v_mov_b32 v17, v28
    v_mul_f32 v22, v22, v29
    s_waitcnt lgkmcnt(0)
    v_fma_f32 v22, v27, v30, v22
    v_lshlrev_b32 v32, 16, v0
    v_and_b32 v33, 0xffff0000, v0
    v_lshlrev_b32 v34, 16, v1
    v_and_b32 v35, 0xffff0000, v1
    v_mul_f32 v32, v32, v30
    v_mul_f32 v33, v33, v30
    v_mul_f32 v34, v34, v30
    v_mul_f32 v35, v35, v30
    v_cvt_pk_bf16_f32 v0, v32, v33
    v_cvt_pk_bf16_f32 v1, v34, v35
    ds_write_b64 v8, v[0:1] offset:8192
    s_waitcnt lgkmcnt(0)
    s_barrier
    v_mov_b32 v28, 0xff800000
    v_mov_b32 v29, 0
    ds_write_b32 v3, v28 offset:0
    ds_write_b32 v12, v29 offset:0
    ds_write_b32 v3, v28 offset:256
    ds_write_b32 v12, v29 offset:256
    ds_write_b32 v3, v28 offset:512
    ds_write_b32 v12, v29 offset:512
    ds_write_b32 v3, v28 offset:768
    ds_write_b32 v12, v29 offset:768
    ds_write_b32 v3, v28 offset:1024
    ds_write_b32 v12, v29 offset:1024
    s_waitcnt lgkmcnt(0)
    v_fma_f32 v28, v44, s32, -v13
    v_fma_f32 v29, v45, s32, -v13
    v_fma_f32 v30, v46, s32, -v13
    v_fma_f32 v31, v47, s32, -v13
    v_exp_f32 v28, v28
    v_exp_f32 v29, v29
    v_exp_f32 v30, v30
    v_exp_f32 v31, v31
    v_cvt_pk_bf16_f32 v0, v28, v29
    v_add_f32 v23, v28, v29
    v_cvt_pk_bf16_f32 v1, v30, v31
    v_add_f32 v30, v30, v31
    v_add_f32 v23, v23, v30
    v_fma_f32 v32, v48, s32, -v14
    v_fma_f32 v33, v49, s32, -v14
    v_fma_f32 v34, v50, s32, -v14
    v_fma_f32 v35, v51, s32, -v14
    v_exp_f32 v32, v32
    v_exp_f32 v33, v33
    v_exp_f32 v34, v34
    v_exp_f32 v35, v35
    v_cvt_pk_bf16_f32 v2, v32, v33
    v_add_f32 v24, v32, v33
    v_cvt_pk_bf16_f32 v3, v34, v35
    v_add_f32 v34, v34, v35
    v_add_f32 v24, v24, v34
    v_fma_f32 v28, v52, s32, -v15
    v_fma_f32 v29, v53, s32, -v15
    v_fma_f32 v30, v54, s32, -v15
    v_fma_f32 v31, v55, s32, -v15
    v_exp_f32 v28, v28
    v_exp_f32 v29, v29
    v_exp_f32 v30, v30
    v_exp_f32 v31, v31
    v_cvt_pk_bf16_f32 v36, v28, v29
    v_add_f32 v25, v28, v29
    v_cvt_pk_bf16_f32 v37, v30, v31
    v_add_f32 v30, v30, v31
    v_add_f32 v25, v25, v30
    v_fma_f32 v32, v56, s32, -v16
    v_fma_f32 v33, v57, s32, -v16
    v_fma_f32 v34, v58, s32, -v16
    v_fma_f32 v35, v59, s32, -v16
    v_exp_f32 v32, v32
    v_exp_f32 v33, v33
    v_exp_f32 v34, v34
    v_exp_f32 v35, v35
    v_cvt_pk_bf16_f32 v38, v32, v33
    v_add_f32 v26, v32, v33
    v_cvt_pk_bf16_f32 v39, v34, v35
    v_add_f32 v34, v34, v35
    v_add_f32 v26, v26, v34
    v_fma_f32 v28, v60, s32, -v17
    v_fma_f32 v29, v61, s32, -v17
    v_fma_f32 v30, v62, s32, -v17
    v_fma_f32 v31, v63, s32, -v17
    v_exp_f32 v28, v28
    v_exp_f32 v29, v29
    v_exp_f32 v30, v30
    v_exp_f32 v31, v31
    v_cvt_pk_bf16_f32 v34, v28, v29
    v_add_f32 v27, v28, v29
    v_cvt_pk_bf16_f32 v35, v30, v31
    v_add_f32 v30, v30, v31
    v_add_f32 v27, v27, v30
    s_nop 3
    s_branch L_retca5
L_slowp5:
    s_waitcnt lgkmcnt(0)
    s_nop 11
    v_mbcnt_lo_u32_b32 v11, -1, 0
    v_mbcnt_hi_u32_b32 v11, -1, v11
    v_and_b32 v11, 15, v11
    v_lshlrev_b32 v11, 4, v11
    v_add_u32 v11, 151552, v11
    s_lshl_b32 s40, s30, 2
    v_add_u32 v11, s40, v11
    v_max3_f32 v32, v44, v45, v46
    v_max_f32 v32, v32, v47
    v_mov_b32 v33, v32
    s_nop 1
    v_permlane16_swap_b32 v32, v33
    s_nop 0
    v_max_f32 v32, v32, v33
    v_mov_b32 v33, v32
    s_nop 1
    v_permlane32_swap_b32 v32, v33
    s_nop 0
    v_max_f32 v32, v32, v33
    v_mul_f32 v32, s32, v32
    v_ceil_f32 v32, v32
    v_max_f32 v32, v32, v13
    ds_write_b32 v11, v32 offset:1280
    v_fma_f32 v28, v44, s32, -v32
    v_fma_f32 v29, v45, s32, -v32
    v_fma_f32 v30, v46, s32, -v32
    v_fma_f32 v31, v47, s32, -v32
    v_exp_f32 v28, v28
    v_exp_f32 v29, v29
    v_exp_f32 v30, v30
    v_exp_f32 v31, v31
    v_cvt_pk_bf16_f32 v0, v28, v29
    v_add_f32 v23, v28, v29
    v_cvt_pk_bf16_f32 v1, v30, v31
    v_add_f32 v30, v30, v31
    v_add_f32 v23, v23, v30
    s_waitcnt lgkmcnt(0)
    v_max3_f32 v28, v48, v49, v50
    v_max_f32 v28, v28, v51
    v_mov_b32 v29, v28
    s_nop 1
    v_permlane16_swap_b32 v28, v29
    s_nop 0
    v_max_f32 v28, v28, v29
    v_mov_b32 v29, v28
    s_nop 1
    v_permlane32_swap_b32 v28, v29
    s_nop 0
    v_max_f32 v28, v28, v29
    v_mul_f32 v28, s32, v28
    v_ceil_f32 v28, v28
    v_max_f32 v28, v28, v14
    ds_write_b32 v11, v28 offset:1536
    v_fma_f32 v32, v48, s32, -v28
    v_fma_f32 v33, v49, s32, -v28
    v_fma_f32 v34, v50, s32, -v28
    v_fma_f32 v35, v51, s32, -v28
    v_exp_f32 v32, v32
    v_exp_f32 v33, v33
    v_exp_f32 v34, v34
    v_exp_f32 v35, v35
    v_cvt_pk_bf16_f32 v2, v32, v33
    v_add_f32 v24, v32, v33
    v_cvt_pk_bf16_f32 v3, v34, v35
    v_add_f32 v34, v34, v35
    v_add_f32 v24, v24, v34
    s_waitcnt lgkmcnt(0)
    v_max3_f32 v32, v52, v53, v54
    v_max_f32 v32, v32, v55
    v_mov_b32 v33, v32
    s_nop 1
    v_permlane16_swap_b32 v32, v33
    s_nop 0
    v_max_f32 v32, v32, v33
    v_mov_b32 v33, v32
    s_nop 1
    v_permlane32_swap_b32 v32, v33
    s_nop 0
    v_max_f32 v32, v32, v33
    v_mul_f32 v32, s32, v32
    v_ceil_f32 v32, v32
    v_max_f32 v32, v32, v15
    ds_write_b32 v11, v32 offset:1792
    v_fma_f32 v28, v52, s32, -v32
    v_fma_f32 v29, v53, s32, -v32
    v_fma_f32 v30, v54, s32, -v32
    v_fma_f32 v31, v55, s32, -v32
    v_exp_f32 v28, v28
    v_exp_f32 v29, v29
    v_exp_f32 v30, v30
    v_exp_f32 v31, v31
    v_cvt_pk_bf16_f32 v36, v28, v29
    v_add_f32 v25, v28, v29
    v_cvt_pk_bf16_f32 v37, v30, v31
    v_add_f32 v30, v30, v31
    v_add_f32 v25, v25, v30
    s_waitcnt lgkmcnt(0)
    v_max3_f32 v28, v56, v57, v58
    v_max_f32 v28, v28, v59
    v_mov_b32 v29, v28
    s_nop 1
    v_permlane16_swap_b32 v28, v29
    s_nop 0
    v_max_f32 v28, v28, v29
    v_mov_b32 v29, v28
    s_nop 1
    v_permlane32_swap_b32 v28, v29
    s_nop 0
    v_max_f32 v28, v28, v29
    v_mul_f32 v28, s32, v28
    v_ceil_f32 v28, v28
    v_max_f32 v28, v28, v16
    ds_write_b32 v11, v28 offset:2048
    v_fma_f32 v32, v56, s32, -v28
    v_fma_f32 v33, v57, s32, -v28
    v_fma_f32 v34, v58, s32, -v28
    v_fma_f32 v35, v59, s32, -v28
    v_exp_f32 v32, v32
    v_exp_f32 v33, v33
    v_exp_f32 v34, v34
    v_exp_f32 v35, v35
    v_cvt_pk_bf16_f32 v38, v32, v33
    v_add_f32 v26, v32, v33
    v_cvt_pk_bf16_f32 v39, v34, v35
    v_add_f32 v34, v34, v35
    v_add_f32 v26, v26, v34
    s_waitcnt lgkmcnt(0)
    v_max3_f32 v32, v60, v61, v62
    v_max_f32 v32, v32, v63
    v_mov_b32 v33, v32
    s_nop 1
    v_permlane16_swap_b32 v32, v33
    s_nop 0
    v_max_f32 v32, v32, v33
    v_mov_b32 v33, v32
    s_nop 1
    v_permlane32_swap_b32 v32, v33
    s_nop 0
    v_max_f32 v32, v32, v33
    v_mul_f32 v32, s32, v32
    v_ceil_f32 v32, v32
    v_max_f32 v32, v32, v17
    ds_write_b32 v11, v32 offset:2304
    v_fma_f32 v28, v60, s32, -v32
    v_fma_f32 v29, v61, s32, -v32
    v_fma_f32 v30, v62, s32, -v32
    v_fma_f32 v31, v63, s32, -v32
    v_exp_f32 v28, v28
    v_exp_f32 v29, v29
    v_exp_f32 v30, v30
    v_exp_f32 v31, v31
    v_cvt_pk_bf16_f32 v34, v28, v29
    v_add_f32 v27, v28, v29
    v_cvt_pk_bf16_f32 v35, v30, v31
    v_add_f32 v30, v30, v31
    v_add_f32 v27, v27, v30
    s_waitcnt lgkmcnt(0)
    v_mbcnt_lo_u32_b32 v11, -1, 0
    v_mbcnt_hi_u32_b32 v11, -1, v11
    v_lshlrev_b32 v11, 2, v11
    s_mul_i32 s40, s30, 1280
    s_add_u32 s40, s40, 155648
    v_add_u32 v11, s40, v11
    ds_write_b32 v11, v23 offset:0
    v_mov_b32 v23, 0
    ds_write_b32 v11, v24 offset:256
    v_mov_b32 v24, 0
    ds_write_b32 v11, v25 offset:512
    v_mov_b32 v25, 0
    ds_write_b32 v11, v26 offset:768
    v_mov_b32 v26, 0
    ds_write_b32 v11, v27 offset:1024
    v_mov_b32 v27, 0
    s_waitcnt lgkmcnt(0)
    v_or_b32 v12, 0x10000, v12
    s_nop 3
    s_branch L_retp5
L_slowca6:
    v_and_b32 v12, 0xffff, v11
    v_cmp_ne_u32 vcc, s39, v12
    s_cbranch_vccz L_slowca6_ready
    s_sleep 1
    ds_read_b32 v11, v9 offset:32
    s_waitcnt lgkmcnt(0)
    v_cmp_ne_u32 vcc, s39, v11
    s_cbranch_vccz L_retca6
    s_branch L_slowca6
L_slowca6_ready:
    s_waitcnt lgkmcnt(0)
    s_nop 11
    v_mbcnt_lo_u32_b32 v11, -1, 0
    v_mbcnt_hi_u32_b32 v11, -1, v11
    v_and_b32 v11, 15, v11
    v_lshlrev_b32 v11, 4, v11
    v_add_u32 v11, 151552, v11
    s_lshl_b32 s40, s30, 2
    v_add_u32 v3, s40, v11
    v_mbcnt_lo_u32_b32 v12, -1, 0
    v_mbcnt_hi_u32_b32 v12, -1, v12
    v_lshlrev_b32 v12, 2, v12
    s_mul_i32 s40, s30, 1280
    s_add_u32 s40, s40, 155648
    v_add_u32 v12, s40, v12
    ds_read_b128 v[28:31], v11 offset:1280
    ds_read_b32 v2, v3 offset:1280
    ds_read_b64 v[0:1], v8 offset:10240
    ds_read_b32 v23, v12 offset:0
    s_waitcnt lgkmcnt(3)
    v_max3_f32 v28, v28, v29, v30
    v_max3_f32 v28, v28, v31, v13
    s_waitcnt lgkmcnt(2)
    v_max_f32 v2, v2, v13
    v_sub_f32 v29, v13, v28
    v_sub_f32 v30, v2, v28
    v_exp_f32 v29, v29
    v_exp_f32 v30, v30
    v_mov_b32 v13, v28
    v_mul_f32 v18, v18, v29
    s_waitcnt lgkmcnt(0)
    v_fma_f32 v18, v23, v30, v18
    v_lshlrev_b32 v32, 16, v0
    v_and_b32 v33, 0xffff0000, v0
    v_lshlrev_b32 v34, 16, v1
    v_and_b32 v35, 0xffff0000, v1
    v_mul_f32 v32, v32, v30
    v_mul_f32 v33, v33, v30
    v_mul_f32 v34, v34, v30
    v_mul_f32 v35, v35, v30
    v_cvt_pk_bf16_f32 v0, v32, v33
    v_cvt_pk_bf16_f32 v1, v34, v35
    ds_write_b64 v8, v[0:1] offset:10240
    s_waitcnt lgkmcnt(0)
    ds_read_b128 v[28:31], v11 offset:1536
    ds_read_b32 v2, v3 offset:1536
    ds_read_b64 v[0:1], v8 offset:12288
    ds_read_b32 v24, v12 offset:256
    s_waitcnt lgkmcnt(3)
    v_max3_f32 v28, v28, v29, v30
    v_max3_f32 v28, v28, v31, v14
    s_waitcnt lgkmcnt(2)
    v_max_f32 v2, v2, v14
    v_sub_f32 v29, v14, v28
    v_sub_f32 v30, v2, v28
    v_exp_f32 v29, v29
    v_exp_f32 v30, v30
    v_mov_b32 v14, v28
    v_mul_f32 v19, v19, v29
    s_waitcnt lgkmcnt(0)
    v_fma_f32 v19, v24, v30, v19
    v_lshlrev_b32 v32, 16, v0
    v_and_b32 v33, 0xffff0000, v0
    v_lshlrev_b32 v34, 16, v1
    v_and_b32 v35, 0xffff0000, v1
    v_mul_f32 v32, v32, v30
    v_mul_f32 v33, v33, v30
    v_mul_f32 v34, v34, v30
    v_mul_f32 v35, v35, v30
    v_cvt_pk_bf16_f32 v0, v32, v33
    v_cvt_pk_bf16_f32 v1, v34, v35
    ds_write_b64 v8, v[0:1] offset:12288
    s_waitcnt lgkmcnt(0)
    ds_read_b128 v[28:31], v11 offset:1792
    ds_read_b32 v2, v3 offset:1792
    ds_read_b64 v[0:1], v8 offset:14336
    ds_read_b32 v25, v12 offset:512
    s_waitcnt lgkmcnt(3)
    v_max3_f32 v28, v28, v29, v30
    v_max3_f32 v28, v28, v31, v15
    s_waitcnt lgkmcnt(2)
    v_max_f32 v2, v2, v15
    v_sub_f32 v29, v15, v28
    v_sub_f32 v30, v2, v28
    v_exp_f32 v29, v29
    v_exp_f32 v30, v30
    v_mov_b32 v15, v28
    v_mul_f32 v20, v20, v29
    s_waitcnt lgkmcnt(0)
    v_fma_f32 v20, v25, v30, v20
    v_lshlrev_b32 v32, 16, v0
    v_and_b32 v33, 0xffff0000, v0
    v_lshlrev_b32 v34, 16, v1
    v_and_b32 v35, 0xffff0000, v1
    v_mul_f32 v32, v32, v30
    v_mul_f32 v33, v33, v30
    v_mul_f32 v34, v34, v30
    v_mul_f32 v35, v35, v30
    v_cvt_pk_bf16_f32 v0, v32, v33
    v_cvt_pk_bf16_f32 v1, v34, v35
    ds_write_b64 v8, v[0:1] offset:14336
    s_waitcnt lgkmcnt(0)
    ds_read_b128 v[28:31], v11 offset:2048
    ds_read_b32 v2, v3 offset:2048
    ds_read_b64 v[0:1], v8 offset:16384
    ds_read_b32 v26, v12 offset:768
    s_waitcnt lgkmcnt(3)
    v_max3_f32 v28, v28, v29, v30
    v_max3_f32 v28, v28, v31, v16
    s_waitcnt lgkmcnt(2)
    v_max_f32 v2, v2, v16
    v_sub_f32 v29, v16, v28
    v_sub_f32 v30, v2, v28
    v_exp_f32 v29, v29
    v_exp_f32 v30, v30
    v_mov_b32 v16, v28
    v_mul_f32 v21, v21, v29
    s_waitcnt lgkmcnt(0)
    v_fma_f32 v21, v26, v30, v21
    v_lshlrev_b32 v32, 16, v0
    v_and_b32 v33, 0xffff0000, v0
    v_lshlrev_b32 v34, 16, v1
    v_and_b32 v35, 0xffff0000, v1
    v_mul_f32 v32, v32, v30
    v_mul_f32 v33, v33, v30
    v_mul_f32 v34, v34, v30
    v_mul_f32 v35, v35, v30
    v_cvt_pk_bf16_f32 v0, v32, v33
    v_cvt_pk_bf16_f32 v1, v34, v35
    ds_write_b64 v8, v[0:1] offset:16384
    s_waitcnt lgkmcnt(0)
    ds_read_b128 v[28:31], v11 offset:2304
    ds_read_b32 v2, v3 offset:2304
    ds_read_b64 v[0:1], v8 offset:18432
    ds_read_b32 v27, v12 offset:1024
    s_waitcnt lgkmcnt(3)
    v_max3_f32 v28, v28, v29, v30
    v_max3_f32 v28, v28, v31, v17
    s_waitcnt lgkmcnt(2)
    v_max_f32 v2, v2, v17
    v_sub_f32 v29, v17, v28
    v_sub_f32 v30, v2, v28
    v_exp_f32 v29, v29
    v_exp_f32 v30, v30
    v_mov_b32 v17, v28
    v_mul_f32 v22, v22, v29
    s_waitcnt lgkmcnt(0)
    v_fma_f32 v22, v27, v30, v22
    v_lshlrev_b32 v32, 16, v0
    v_and_b32 v33, 0xffff0000, v0
    v_lshlrev_b32 v34, 16, v1
    v_and_b32 v35, 0xffff0000, v1
    v_mul_f32 v32, v32, v30
    v_mul_f32 v33, v33, v30
    v_mul_f32 v34, v34, v30
    v_mul_f32 v35, v35, v30
    v_cvt_pk_bf16_f32 v0, v32, v33
    v_cvt_pk_bf16_f32 v1, v34, v35
    ds_write_b64 v8, v[0:1] offset:18432
    s_waitcnt lgkmcnt(0)
    s_barrier
    v_mov_b32 v28, 0xff800000
    v_mov_b32 v29, 0
    ds_write_b32 v3, v28 offset:1280
    ds_write_b32 v12, v29 offset:0
    ds_write_b32 v3, v28 offset:1536
    ds_write_b32 v12, v29 offset:256
    ds_write_b32 v3, v28 offset:1792
    ds_write_b32 v12, v29 offset:512
    ds_write_b32 v3, v28 offset:2048
    ds_write_b32 v12, v29 offset:768
    ds_write_b32 v3, v28 offset:2304
    ds_write_b32 v12, v29 offset:1024
    s_waitcnt lgkmcnt(0)
    s_nop 3
    s_branch L_retca6
L_slowca9:
    v_and_b32 v12, 0xffff, v11
    v_cmp_ne_u32 vcc, s39, v12
    s_cbranch_vccz L_slowca9_ready
    s_sleep 1
    ds_read_b32 v11, v9 offset:32
    s_waitcnt lgkmcnt(0)
    v_cmp_ne_u32 vcc, s39, v11
    s_cbranch_vccz L_retca9
    s_branch L_slowca9
L_slowca9_ready:
    s_waitcnt lgkmcnt(0)
    s_nop 11
    v_mbcnt_lo_u32_b32 v11, -1, 0
    v_mbcnt_hi_u32_b32 v11, -1, v11
    v_and_b32 v11, 15, v11
    v_lshlrev_b32 v11, 4, v11
    v_add_u32 v11, 151552, v11
    s_lshl_b32 s40, s30, 2
    v_add_u32 v3, s40, v11
    v_mbcnt_lo_u32_b32 v12, -1, 0
    v_mbcnt_hi_u32_b32 v12, -1, v12
    v_lshlrev_b32 v12, 2, v12
    s_mul_i32 s40, s30, 1280
    s_add_u32 s40, s40, 155648
    v_add_u32 v12, s40, v12
    ds_read_b128 v[28:31], v11 offset:1280
    ds_read_b32 v2, v3 offset:1280
    ds_read_b64 v[0:1], v8 offset:10240
    ds_read_b32 v23, v12 offset:0
    s_waitcnt lgkmcnt(3)
    v_max3_f32 v28, v28, v29, v30
    v_max3_f32 v28, v28, v31, v13
    s_waitcnt lgkmcnt(2)
    v_max_f32 v2, v2, v13
    v_sub_f32 v29, v13, v28
    v_sub_f32 v30, v2, v28
    v_exp_f32 v29, v29
    v_exp_f32 v30, v30
    v_mov_b32 v13, v28
    v_mul_f32 v18, v18, v29
    s_waitcnt lgkmcnt(0)
    v_fma_f32 v18, v23, v30, v18
    v_lshlrev_b32 v32, 16, v0
    v_and_b32 v33, 0xffff0000, v0
    v_lshlrev_b32 v34, 16, v1
    v_and_b32 v35, 0xffff0000, v1
    v_mul_f32 v32, v32, v30
    v_mul_f32 v33, v33, v30
    v_mul_f32 v34, v34, v30
    v_mul_f32 v35, v35, v30
    v_cvt_pk_bf16_f32 v0, v32, v33
    v_cvt_pk_bf16_f32 v1, v34, v35
    ds_write_b64 v8, v[0:1] offset:10240
    s_waitcnt lgkmcnt(0)
    ds_read_b128 v[28:31], v11 offset:1536
    ds_read_b32 v2, v3 offset:1536
    ds_read_b64 v[0:1], v8 offset:12288
    ds_read_b32 v24, v12 offset:256
    s_waitcnt lgkmcnt(3)
    v_max3_f32 v28, v28, v29, v30
    v_max3_f32 v28, v28, v31, v14
    s_waitcnt lgkmcnt(2)
    v_max_f32 v2, v2, v14
    v_sub_f32 v29, v14, v28
    v_sub_f32 v30, v2, v28
    v_exp_f32 v29, v29
    v_exp_f32 v30, v30
    v_mov_b32 v14, v28
    v_mul_f32 v19, v19, v29
    s_waitcnt lgkmcnt(0)
    v_fma_f32 v19, v24, v30, v19
    v_lshlrev_b32 v32, 16, v0
    v_and_b32 v33, 0xffff0000, v0
    v_lshlrev_b32 v34, 16, v1
    v_and_b32 v35, 0xffff0000, v1
    v_mul_f32 v32, v32, v30
    v_mul_f32 v33, v33, v30
    v_mul_f32 v34, v34, v30
    v_mul_f32 v35, v35, v30
    v_cvt_pk_bf16_f32 v0, v32, v33
    v_cvt_pk_bf16_f32 v1, v34, v35
    ds_write_b64 v8, v[0:1] offset:12288
    s_waitcnt lgkmcnt(0)
    ds_read_b128 v[28:31], v11 offset:1792
    ds_read_b32 v2, v3 offset:1792
    ds_read_b64 v[0:1], v8 offset:14336
    ds_read_b32 v25, v12 offset:512
    s_waitcnt lgkmcnt(3)
    v_max3_f32 v28, v28, v29, v30
    v_max3_f32 v28, v28, v31, v15
    s_waitcnt lgkmcnt(2)
    v_max_f32 v2, v2, v15
    v_sub_f32 v29, v15, v28
    v_sub_f32 v30, v2, v28
    v_exp_f32 v29, v29
    v_exp_f32 v30, v30
    v_mov_b32 v15, v28
    v_mul_f32 v20, v20, v29
    s_waitcnt lgkmcnt(0)
    v_fma_f32 v20, v25, v30, v20
    v_lshlrev_b32 v32, 16, v0
    v_and_b32 v33, 0xffff0000, v0
    v_lshlrev_b32 v34, 16, v1
    v_and_b32 v35, 0xffff0000, v1
    v_mul_f32 v32, v32, v30
    v_mul_f32 v33, v33, v30
    v_mul_f32 v34, v34, v30
    v_mul_f32 v35, v35, v30
    v_cvt_pk_bf16_f32 v0, v32, v33
    v_cvt_pk_bf16_f32 v1, v34, v35
    ds_write_b64 v8, v[0:1] offset:14336
    s_waitcnt lgkmcnt(0)
    ds_read_b128 v[28:31], v11 offset:2048
    ds_read_b32 v2, v3 offset:2048
    ds_read_b64 v[0:1], v8 offset:16384
    ds_read_b32 v26, v12 offset:768
    s_waitcnt lgkmcnt(3)
    v_max3_f32 v28, v28, v29, v30
    v_max3_f32 v28, v28, v31, v16
    s_waitcnt lgkmcnt(2)
    v_max_f32 v2, v2, v16
    v_sub_f32 v29, v16, v28
    v_sub_f32 v30, v2, v28
    v_exp_f32 v29, v29
    v_exp_f32 v30, v30
    v_mov_b32 v16, v28
    v_mul_f32 v21, v21, v29
    s_waitcnt lgkmcnt(0)
    v_fma_f32 v21, v26, v30, v21
    v_lshlrev_b32 v32, 16, v0
    v_and_b32 v33, 0xffff0000, v0
    v_lshlrev_b32 v34, 16, v1
    v_and_b32 v35, 0xffff0000, v1
    v_mul_f32 v32, v32, v30
    v_mul_f32 v33, v33, v30
    v_mul_f32 v34, v34, v30
    v_mul_f32 v35, v35, v30
    v_cvt_pk_bf16_f32 v0, v32, v33
    v_cvt_pk_bf16_f32 v1, v34, v35
    ds_write_b64 v8, v[0:1] offset:16384
    s_waitcnt lgkmcnt(0)
    s_barrier
    v_mov_b32 v28, 0xff800000
    v_mov_b32 v29, 0
    ds_write_b32 v3, v28 offset:1280
    ds_write_b32 v12, v29 offset:0
    ds_write_b32 v3, v28 offset:1536
    ds_write_b32 v12, v29 offset:256
    ds_write_b32 v3, v28 offset:1792
    ds_write_b32 v12, v29 offset:512
    ds_write_b32 v3, v28 offset:2048
    ds_write_b32 v12, v29 offset:768
    s_waitcnt lgkmcnt(0)
    v_fma_f32 v28, v40, s32, -v13
    v_fma_f32 v29, v41, s32, -v13
    v_fma_f32 v30, v42, s32, -v13
    v_fma_f32 v31, v43, s32, -v13
    v_exp_f32 v28, v28
    v_exp_f32 v29, v29
    v_exp_f32 v30, v30
    v_exp_f32 v31, v31
    v_cvt_pk_bf16_f32 v0, v28, v29
    v_add_f32 v23, v28, v29
    v_cvt_pk_bf16_f32 v1, v30, v31
    v_add_f32 v30, v30, v31
    v_add_f32 v23, v23, v30
    v_fma_f32 v32, v48, s32, -v14
    v_fma_f32 v33, v49, s32, -v14
    v_fma_f32 v34, v50, s32, -v14
    v_fma_f32 v35, v51, s32, -v14
    v_exp_f32 v32, v32
    v_exp_f32 v33, v33
    v_exp_f32 v34, v34
    v_exp_f32 v35, v35
    v_cvt_pk_bf16_f32 v2, v32, v33
    v_add_f32 v24, v32, v33
    v_cvt_pk_bf16_f32 v3, v34, v35
    v_add_f32 v34, v34, v35
    v_add_f32 v24, v24, v34
    v_fma_f32 v28, v52, s32, -v15
    v_fma_f32 v29, v53, s32, -v15
    v_fma_f32 v30, v54, s32, -v15
    v_fma_f32 v31, v55, s32, -v15
    v_exp_f32 v28, v28
    v_exp_f32 v29, v29
    v_exp_f32 v30, v30
    v_exp_f32 v31, v31
    v_cvt_pk_bf16_f32 v36, v28, v29
    v_add_f32 v25, v28, v29
    v_cvt_pk_bf16_f32 v37, v30, v31
    v_add_f32 v30, v30, v31
    v_add_f32 v25, v25, v30
    v_fma_f32 v32, v56, s32, -v16
    v_fma_f32 v33, v57, s32, -v16
    v_fma_f32 v34, v58, s32, -v16
    v_fma_f32 v35, v59, s32, -v16
    v_exp_f32 v32, v32
    v_exp_f32 v33, v33
    v_exp_f32 v34, v34
    v_exp_f32 v35, v35
    v_cvt_pk_bf16_f32 v38, v32, v33
    v_add_f32 v26, v32, v33
    v_cvt_pk_bf16_f32 v39, v34, v35
    v_add_f32 v34, v34, v35
    v_add_f32 v26, v26, v34
    s_nop 3
    s_branch L_retca9
L_slowp9:
    s_waitcnt lgkmcnt(0)
    s_nop 11
    v_mbcnt_lo_u32_b32 v11, -1, 0
    v_mbcnt_hi_u32_b32 v11, -1, v11
    v_and_b32 v11, 15, v11
    v_lshlrev_b32 v11, 4, v11
    v_add_u32 v11, 151552, v11
    s_lshl_b32 s40, s30, 2
    v_add_u32 v11, s40, v11
    v_max3_f32 v32, v40, v41, v42
    v_max_f32 v32, v32, v43
    v_mov_b32 v33, v32
    s_nop 1
    v_permlane16_swap_b32 v32, v33
    s_nop 0
    v_max_f32 v32, v32, v33
    v_mov_b32 v33, v32
    s_nop 1
    v_permlane32_swap_b32 v32, v33
    s_nop 0
    v_max_f32 v32, v32, v33
    v_mul_f32 v32, s32, v32
    v_ceil_f32 v32, v32
    v_max_f32 v32, v32, v13
    ds_write_b32 v11, v32 offset:0
    v_fma_f32 v28, v40, s32, -v32
    v_fma_f32 v29, v41, s32, -v32
    v_fma_f32 v30, v42, s32, -v32
    v_fma_f32 v31, v43, s32, -v32
    v_exp_f32 v28, v28
    v_exp_f32 v29, v29
    v_exp_f32 v30, v30
    v_exp_f32 v31, v31
    v_cvt_pk_bf16_f32 v0, v28, v29
    v_add_f32 v23, v28, v29
    v_cvt_pk_bf16_f32 v1, v30, v31
    v_add_f32 v30, v30, v31
    v_add_f32 v23, v23, v30
    s_waitcnt lgkmcnt(0)
    v_max3_f32 v28, v48, v49, v50
    v_max_f32 v28, v28, v51
    v_mov_b32 v29, v28
    s_nop 1
    v_permlane16_swap_b32 v28, v29
    s_nop 0
    v_max_f32 v28, v28, v29
    v_mov_b32 v29, v28
    s_nop 1
    v_permlane32_swap_b32 v28, v29
    s_nop 0
    v_max_f32 v28, v28, v29
    v_mul_f32 v28, s32, v28
    v_ceil_f32 v28, v28
    v_max_f32 v28, v28, v14
    ds_write_b32 v11, v28 offset:256
    v_fma_f32 v32, v48, s32, -v28
    v_fma_f32 v33, v49, s32, -v28
    v_fma_f32 v34, v50, s32, -v28
    v_fma_f32 v35, v51, s32, -v28
    v_exp_f32 v32, v32
    v_exp_f32 v33, v33
    v_exp_f32 v34, v34
    v_exp_f32 v35, v35
    v_cvt_pk_bf16_f32 v2, v32, v33
    v_add_f32 v24, v32, v33
    v_cvt_pk_bf16_f32 v3, v34, v35
    v_add_f32 v34, v34, v35
    v_add_f32 v24, v24, v34
    s_waitcnt lgkmcnt(0)
    v_max3_f32 v32, v52, v53, v54
    v_max_f32 v32, v32, v55
    v_mov_b32 v33, v32
    s_nop 1
    v_permlane16_swap_b32 v32, v33
    s_nop 0
    v_max_f32 v32, v32, v33
    v_mov_b32 v33, v32
    s_nop 1
    v_permlane32_swap_b32 v32, v33
    s_nop 0
    v_max_f32 v32, v32, v33
    v_mul_f32 v32, s32, v32
    v_ceil_f32 v32, v32
    v_max_f32 v32, v32, v15
    ds_write_b32 v11, v32 offset:512
    v_fma_f32 v28, v52, s32, -v32
    v_fma_f32 v29, v53, s32, -v32
    v_fma_f32 v30, v54, s32, -v32
    v_fma_f32 v31, v55, s32, -v32
    v_exp_f32 v28, v28
    v_exp_f32 v29, v29
    v_exp_f32 v30, v30
    v_exp_f32 v31, v31
    v_cvt_pk_bf16_f32 v36, v28, v29
    v_add_f32 v25, v28, v29
    v_cvt_pk_bf16_f32 v37, v30, v31
    v_add_f32 v30, v30, v31
    v_add_f32 v25, v25, v30
    s_waitcnt lgkmcnt(0)
    v_max3_f32 v28, v56, v57, v58
    v_max_f32 v28, v28, v59
    v_mov_b32 v29, v28
    s_nop 1
    v_permlane16_swap_b32 v28, v29
    s_nop 0
    v_max_f32 v28, v28, v29
    v_mov_b32 v29, v28
    s_nop 1
    v_permlane32_swap_b32 v28, v29
    s_nop 0
    v_max_f32 v28, v28, v29
    v_mul_f32 v28, s32, v28
    v_ceil_f32 v28, v28
    v_max_f32 v28, v28, v16
    ds_write_b32 v11, v28 offset:768
    v_fma_f32 v32, v56, s32, -v28
    v_fma_f32 v33, v57, s32, -v28
    v_fma_f32 v34, v58, s32, -v28
    v_fma_f32 v35, v59, s32, -v28
    v_exp_f32 v32, v32
    v_exp_f32 v33, v33
    v_exp_f32 v34, v34
    v_exp_f32 v35, v35
    v_cvt_pk_bf16_f32 v38, v32, v33
    v_add_f32 v26, v32, v33
    v_cvt_pk_bf16_f32 v39, v34, v35
    v_add_f32 v34, v34, v35
    v_add_f32 v26, v26, v34
    s_waitcnt lgkmcnt(0)
    v_mbcnt_lo_u32_b32 v11, -1, 0
    v_mbcnt_hi_u32_b32 v11, -1, v11
    v_lshlrev_b32 v11, 2, v11
    s_mul_i32 s40, s30, 1280
    s_add_u32 s40, s40, 155648
    v_add_u32 v11, s40, v11
    ds_write_b32 v11, v23 offset:0
    v_mov_b32 v23, 0
    ds_write_b32 v11, v24 offset:256
    v_mov_b32 v24, 0
    ds_write_b32 v11, v25 offset:512
    v_mov_b32 v25, 0
    ds_write_b32 v11, v26 offset:768
    v_mov_b32 v26, 0
    s_waitcnt lgkmcnt(0)
    v_or_b32 v12, 0x10000, v12
    s_nop 3
    s_branch L_retp9
L_slowca10:
    v_and_b32 v12, 0xffff, v11
    v_cmp_ne_u32 vcc, s39, v12
    s_cbranch_vccz L_slowca10_ready
    s_sleep 1
    ds_read_b32 v11, v9 offset:0
    s_waitcnt lgkmcnt(0)
    v_cmp_ne_u32 vcc, s39, v11
    s_cbranch_vccz L_retca10
    s_branch L_slowca10
L_slowca10_ready:
    s_waitcnt lgkmcnt(0)
    s_nop 11
    v_mbcnt_lo_u32_b32 v11, -1, 0
    v_mbcnt_hi_u32_b32 v11, -1, v11
    v_and_b32 v11, 15, v11
    v_lshlrev_b32 v11, 4, v11
    v_add_u32 v11, 151552, v11
    s_lshl_b32 s40, s30, 2
    v_add_u32 v3, s40, v11
    v_mbcnt_lo_u32_b32 v12, -1, 0
    v_mbcnt_hi_u32_b32 v12, -1, v12
    v_lshlrev_b32 v12, 2, v12
    s_mul_i32 s40, s30, 1280
    s_add_u32 s40, s40, 155648
    v_add_u32 v12, s40, v12
    ds_read_b128 v[28:31], v11 offset:0
    ds_read_b32 v2, v3 offset:0
    ds_read_b64 v[0:1], v8 offset:0
    ds_read_b32 v23, v12 offset:0
    s_waitcnt lgkmcnt(3)
    v_max3_f32 v28, v28, v29, v30
    v_max3_f32 v28, v28, v31, v13
    s_waitcnt lgkmcnt(2)
    v_max_f32 v2, v2, v13
    v_sub_f32 v29, v13, v28
    v_sub_f32 v30, v2, v28
    v_exp_f32 v29, v29
    v_exp_f32 v30, v30
    v_mov_b32 v13, v28
    v_mul_f32 v18, v18, v29
    s_waitcnt lgkmcnt(0)
    v_fma_f32 v18, v23, v30, v18
    v_lshlrev_b32 v32, 16, v0
    v_and_b32 v33, 0xffff0000, v0
    v_lshlrev_b32 v34, 16, v1
    v_and_b32 v35, 0xffff0000, v1
    v_mul_f32 v32, v32, v30
    v_mul_f32 v33, v33, v30
    v_mul_f32 v34, v34, v30
    v_mul_f32 v35, v35, v30
    v_cvt_pk_bf16_f32 v0, v32, v33
    v_cvt_pk_bf16_f32 v1, v34, v35
    ds_write_b64 v8, v[0:1] offset:0
    s_waitcnt lgkmcnt(0)
    ds_read_b128 v[28:31], v11 offset:256
    ds_read_b32 v2, v3 offset:256
    ds_read_b64 v[0:1], v8 offset:2048
    ds_read_b32 v24, v12 offset:256
    s_waitcnt lgkmcnt(3)
    v_max3_f32 v28, v28, v29, v30
    v_max3_f32 v28, v28, v31, v14
    s_waitcnt lgkmcnt(2)
    v_max_f32 v2, v2, v14
    v_sub_f32 v29, v14, v28
    v_sub_f32 v30, v2, v28
    v_exp_f32 v29, v29
    v_exp_f32 v30, v30
    v_mov_b32 v14, v28
    v_mul_f32 v19, v19, v29
    s_waitcnt lgkmcnt(0)
    v_fma_f32 v19, v24, v30, v19
    v_lshlrev_b32 v32, 16, v0
    v_and_b32 v33, 0xffff0000, v0
    v_lshlrev_b32 v34, 16, v1
    v_and_b32 v35, 0xffff0000, v1
    v_mul_f32 v32, v32, v30
    v_mul_f32 v33, v33, v30
    v_mul_f32 v34, v34, v30
    v_mul_f32 v35, v35, v30
    v_cvt_pk_bf16_f32 v0, v32, v33
    v_cvt_pk_bf16_f32 v1, v34, v35
    ds_write_b64 v8, v[0:1] offset:2048
    s_waitcnt lgkmcnt(0)
    ds_read_b128 v[28:31], v11 offset:512
    ds_read_b32 v2, v3 offset:512
    ds_read_b64 v[0:1], v8 offset:4096
    ds_read_b32 v25, v12 offset:512
    s_waitcnt lgkmcnt(3)
    v_max3_f32 v28, v28, v29, v30
    v_max3_f32 v28, v28, v31, v15
    s_waitcnt lgkmcnt(2)
    v_max_f32 v2, v2, v15
    v_sub_f32 v29, v15, v28
    v_sub_f32 v30, v2, v28
    v_exp_f32 v29, v29
    v_exp_f32 v30, v30
    v_mov_b32 v15, v28
    v_mul_f32 v20, v20, v29
    s_waitcnt lgkmcnt(0)
    v_fma_f32 v20, v25, v30, v20
    v_lshlrev_b32 v32, 16, v0
    v_and_b32 v33, 0xffff0000, v0
    v_lshlrev_b32 v34, 16, v1
    v_and_b32 v35, 0xffff0000, v1
    v_mul_f32 v32, v32, v30
    v_mul_f32 v33, v33, v30
    v_mul_f32 v34, v34, v30
    v_mul_f32 v35, v35, v30
    v_cvt_pk_bf16_f32 v0, v32, v33
    v_cvt_pk_bf16_f32 v1, v34, v35
    ds_write_b64 v8, v[0:1] offset:4096
    s_waitcnt lgkmcnt(0)
    ds_read_b128 v[28:31], v11 offset:768
    ds_read_b32 v2, v3 offset:768
    ds_read_b64 v[0:1], v8 offset:6144
    ds_read_b32 v26, v12 offset:768
    s_waitcnt lgkmcnt(3)
    v_max3_f32 v28, v28, v29, v30
    v_max3_f32 v28, v28, v31, v16
    s_waitcnt lgkmcnt(2)
    v_max_f32 v2, v2, v16
    v_sub_f32 v29, v16, v28
    v_sub_f32 v30, v2, v28
    v_exp_f32 v29, v29
    v_exp_f32 v30, v30
    v_mov_b32 v16, v28
    v_mul_f32 v21, v21, v29
    s_waitcnt lgkmcnt(0)
    v_fma_f32 v21, v26, v30, v21
    v_lshlrev_b32 v32, 16, v0
    v_and_b32 v33, 0xffff0000, v0
    v_lshlrev_b32 v34, 16, v1
    v_and_b32 v35, 0xffff0000, v1
    v_mul_f32 v32, v32, v30
    v_mul_f32 v33, v33, v30
    v_mul_f32 v34, v34, v30
    v_mul_f32 v35, v35, v30
    v_cvt_pk_bf16_f32 v0, v32, v33
    v_cvt_pk_bf16_f32 v1, v34, v35
    ds_write_b64 v8, v[0:1] offset:6144
    s_waitcnt lgkmcnt(0)
    s_barrier
    v_mov_b32 v28, 0xff800000
    v_mov_b32 v29, 0
    ds_write_b32 v3, v28 offset:0
    ds_write_b32 v12, v29 offset:0
    ds_write_b32 v3, v28 offset:256
    ds_write_b32 v12, v29 offset:256
    ds_write_b32 v3, v28 offset:512
    ds_write_b32 v12, v29 offset:512
    ds_write_b32 v3, v28 offset:768
    ds_write_b32 v12, v29 offset:768
    s_waitcnt lgkmcnt(0)
    v_fma_f32 v28, v44, s32, -v13
    v_fma_f32 v29, v45, s32, -v13
    v_fma_f32 v30, v46, s32, -v13
    v_fma_f32 v31, v47, s32, -v13
    v_exp_f32 v28, v28
    v_exp_f32 v29, v29
    v_exp_f32 v30, v30
    v_exp_f32 v31, v31
    v_cvt_pk_bf16_f32 v0, v28, v29
    v_add_f32 v23, v28, v29
    v_cvt_pk_bf16_f32 v1, v30, v31
    v_add_f32 v30, v30, v31
    v_add_f32 v23, v23, v30
    v_fma_f32 v32, v48, s32, -v14
    v_fma_f32 v33, v49, s32, -v14
    v_fma_f32 v34, v50, s32, -v14
    v_fma_f32 v35, v51, s32, -v14
    v_exp_f32 v32, v32
    v_exp_f32 v33, v33
    v_exp_f32 v34, v34
    v_exp_f32 v35, v35
    v_cvt_pk_bf16_f32 v2, v32, v33
    v_add_f32 v24, v32, v33
    v_cvt_pk_bf16_f32 v3, v34, v35
    v_add_f32 v34, v34, v35
    v_add_f32 v24, v24, v34
    v_fma_f32 v28, v52, s32, -v15
    v_fma_f32 v29, v53, s32, -v15
    v_fma_f32 v30, v54, s32, -v15
    v_fma_f32 v31, v55, s32, -v15
    v_exp_f32 v28, v28
    v_exp_f32 v29, v29
    v_exp_f32 v30, v30
    v_exp_f32 v31, v31
    v_cvt_pk_bf16_f32 v36, v28, v29
    v_add_f32 v25, v28, v29
    v_cvt_pk_bf16_f32 v37, v30, v31
    v_add_f32 v30, v30, v31
    v_add_f32 v25, v25, v30
    v_fma_f32 v32, v56, s32, -v16
    v_fma_f32 v33, v57, s32, -v16
    v_fma_f32 v34, v58, s32, -v16
    v_fma_f32 v35, v59, s32, -v16
    v_exp_f32 v32, v32
    v_exp_f32 v33, v33
    v_exp_f32 v34, v34
    v_exp_f32 v35, v35
    v_cvt_pk_bf16_f32 v38, v32, v33
    v_add_f32 v26, v32, v33
    v_cvt_pk_bf16_f32 v39, v34, v35
    v_add_f32 v34, v34, v35
    v_add_f32 v26, v26, v34
    s_nop 3
    s_branch L_retca10
L_slowp10:
    s_waitcnt lgkmcnt(0)
    s_nop 11
    v_mbcnt_lo_u32_b32 v11, -1, 0
    v_mbcnt_hi_u32_b32 v11, -1, v11
    v_and_b32 v11, 15, v11
    v_lshlrev_b32 v11, 4, v11
    v_add_u32 v11, 151552, v11
    s_lshl_b32 s40, s30, 2
    v_add_u32 v11, s40, v11
    v_max3_f32 v32, v44, v45, v46
    v_max_f32 v32, v32, v47
    v_mov_b32 v33, v32
    s_nop 1
    v_permlane16_swap_b32 v32, v33
    s_nop 0
    v_max_f32 v32, v32, v33
    v_mov_b32 v33, v32
    s_nop 1
    v_permlane32_swap_b32 v32, v33
    s_nop 0
    v_max_f32 v32, v32, v33
    v_mul_f32 v32, s32, v32
    v_ceil_f32 v32, v32
    v_max_f32 v32, v32, v13
    ds_write_b32 v11, v32 offset:1280
    v_fma_f32 v28, v44, s32, -v32
    v_fma_f32 v29, v45, s32, -v32
    v_fma_f32 v30, v46, s32, -v32
    v_fma_f32 v31, v47, s32, -v32
    v_exp_f32 v28, v28
    v_exp_f32 v29, v29
    v_exp_f32 v30, v30
    v_exp_f32 v31, v31
    v_cvt_pk_bf16_f32 v0, v28, v29
    v_add_f32 v23, v28, v29
    v_cvt_pk_bf16_f32 v1, v30, v31
    v_add_f32 v30, v30, v31
    v_add_f32 v23, v23, v30
    s_waitcnt lgkmcnt(0)
    v_max3_f32 v28, v48, v49, v50
    v_max_f32 v28, v28, v51
    v_mov_b32 v29, v28
    s_nop 1
    v_permlane16_swap_b32 v28, v29
    s_nop 0
    v_max_f32 v28, v28, v29
    v_mov_b32 v29, v28
    s_nop 1
    v_permlane32_swap_b32 v28, v29
    s_nop 0
    v_max_f32 v28, v28, v29
    v_mul_f32 v28, s32, v28
    v_ceil_f32 v28, v28
    v_max_f32 v28, v28, v14
    ds_write_b32 v11, v28 offset:1536
    v_fma_f32 v32, v48, s32, -v28
    v_fma_f32 v33, v49, s32, -v28
    v_fma_f32 v34, v50, s32, -v28
    v_fma_f32 v35, v51, s32, -v28
    v_exp_f32 v32, v32
    v_exp_f32 v33, v33
    v_exp_f32 v34, v34
    v_exp_f32 v35, v35
    v_cvt_pk_bf16_f32 v2, v32, v33
    v_add_f32 v24, v32, v33
    v_cvt_pk_bf16_f32 v3, v34, v35
    v_add_f32 v34, v34, v35
    v_add_f32 v24, v24, v34
    s_waitcnt lgkmcnt(0)
    v_max3_f32 v32, v52, v53, v54
    v_max_f32 v32, v32, v55
    v_mov_b32 v33, v32
    s_nop 1
    v_permlane16_swap_b32 v32, v33
    s_nop 0
    v_max_f32 v32, v32, v33
    v_mov_b32 v33, v32
    s_nop 1
    v_permlane32_swap_b32 v32, v33
    s_nop 0
    v_max_f32 v32, v32, v33
    v_mul_f32 v32, s32, v32
    v_ceil_f32 v32, v32
    v_max_f32 v32, v32, v15
    ds_write_b32 v11, v32 offset:1792
    v_fma_f32 v28, v52, s32, -v32
    v_fma_f32 v29, v53, s32, -v32
    v_fma_f32 v30, v54, s32, -v32
    v_fma_f32 v31, v55, s32, -v32
    v_exp_f32 v28, v28
    v_exp_f32 v29, v29
    v_exp_f32 v30, v30
    v_exp_f32 v31, v31
    v_cvt_pk_bf16_f32 v36, v28, v29
    v_add_f32 v25, v28, v29
    v_cvt_pk_bf16_f32 v37, v30, v31
    v_add_f32 v30, v30, v31
    v_add_f32 v25, v25, v30
    s_waitcnt lgkmcnt(0)
    v_max3_f32 v28, v56, v57, v58
    v_max_f32 v28, v28, v59
    v_mov_b32 v29, v28
    s_nop 1
    v_permlane16_swap_b32 v28, v29
    s_nop 0
    v_max_f32 v28, v28, v29
    v_mov_b32 v29, v28
    s_nop 1
    v_permlane32_swap_b32 v28, v29
    s_nop 0
    v_max_f32 v28, v28, v29
    v_mul_f32 v28, s32, v28
    v_ceil_f32 v28, v28
    v_max_f32 v28, v28, v16
    ds_write_b32 v11, v28 offset:2048
    v_fma_f32 v32, v56, s32, -v28
    v_fma_f32 v33, v57, s32, -v28
    v_fma_f32 v34, v58, s32, -v28
    v_fma_f32 v35, v59, s32, -v28
    v_exp_f32 v32, v32
    v_exp_f32 v33, v33
    v_exp_f32 v34, v34
    v_exp_f32 v35, v35
    v_cvt_pk_bf16_f32 v38, v32, v33
    v_add_f32 v26, v32, v33
    v_cvt_pk_bf16_f32 v39, v34, v35
    v_add_f32 v34, v34, v35
    v_add_f32 v26, v26, v34
    s_waitcnt lgkmcnt(0)
    v_mbcnt_lo_u32_b32 v11, -1, 0
    v_mbcnt_hi_u32_b32 v11, -1, v11
    v_lshlrev_b32 v11, 2, v11
    s_mul_i32 s40, s30, 1280
    s_add_u32 s40, s40, 155648
    v_add_u32 v11, s40, v11
    ds_write_b32 v11, v23 offset:0
    v_mov_b32 v23, 0
    ds_write_b32 v11, v24 offset:256
    v_mov_b32 v24, 0
    ds_write_b32 v11, v25 offset:512
    v_mov_b32 v25, 0
    ds_write_b32 v11, v26 offset:768
    v_mov_b32 v26, 0
    s_waitcnt lgkmcnt(0)
    v_or_b32 v12, 0x10000, v12
    s_nop 3
    s_branch L_retp10
L_slowca11:
    v_and_b32 v12, 0xffff, v11
    v_cmp_ne_u32 vcc, s39, v12
    s_cbranch_vccz L_slowca11_ready
    s_sleep 1
    ds_read_b32 v11, v9 offset:0
    s_waitcnt lgkmcnt(0)
    v_cmp_ne_u32 vcc, s39, v11
    s_cbranch_vccz L_retca11
    s_branch L_slowca11
L_slowca11_ready:
    s_waitcnt lgkmcnt(0)
    s_nop 11
    v_mbcnt_lo_u32_b32 v11, -1, 0
    v_mbcnt_hi_u32_b32 v11, -1, v11
    v_and_b32 v11, 15, v11
    v_lshlrev_b32 v11, 4, v11
    v_add_u32 v11, 151552, v11
    s_lshl_b32 s40, s30, 2
    v_add_u32 v3, s40, v11
    v_mbcnt_lo_u32_b32 v12, -1, 0
    v_mbcnt_hi_u32_b32 v12, -1, v12
    v_lshlrev_b32 v12, 2, v12
    s_mul_i32 s40, s30, 1280
    s_add_u32 s40, s40, 155648
    v_add_u32 v12, s40, v12
    ds_read_b128 v[28:31], v11 offset:0
    ds_read_b32 v2, v3 offset:0
    ds_read_b64 v[0:1], v8 offset:0
    ds_read_b32 v23, v12 offset:0
    s_waitcnt lgkmcnt(3)
    v_max3_f32 v28, v28, v29, v30
    v_max3_f32 v28, v28, v31, v13
    s_waitcnt lgkmcnt(2)
    v_max_f32 v2, v2, v13
    v_sub_f32 v29, v13, v28
    v_sub_f32 v30, v2, v28
    v_exp_f32 v29, v29
    v_exp_f32 v30, v30
    v_mov_b32 v13, v28
    v_mul_f32 v18, v18, v29
    s_waitcnt lgkmcnt(0)
    v_fma_f32 v18, v23, v30, v18
    v_lshlrev_b32 v32, 16, v0
    v_and_b32 v33, 0xffff0000, v0
    v_lshlrev_b32 v34, 16, v1
    v_and_b32 v35, 0xffff0000, v1
    v_mul_f32 v32, v32, v30
    v_mul_f32 v33, v33, v30
    v_mul_f32 v34, v34, v30
    v_mul_f32 v35, v35, v30
    v_cvt_pk_bf16_f32 v0, v32, v33
    v_cvt_pk_bf16_f32 v1, v34, v35
    ds_write_b64 v8, v[0:1] offset:0
    s_waitcnt lgkmcnt(0)
    ds_read_b128 v[28:31], v11 offset:256
    ds_read_b32 v2, v3 offset:256
    ds_read_b64 v[0:1], v8 offset:2048
    ds_read_b32 v24, v12 offset:256
    s_waitcnt lgkmcnt(3)
    v_max3_f32 v28, v28, v29, v30
    v_max3_f32 v28, v28, v31, v14
    s_waitcnt lgkmcnt(2)
    v_max_f32 v2, v2, v14
    v_sub_f32 v29, v14, v28
    v_sub_f32 v30, v2, v28
    v_exp_f32 v29, v29
    v_exp_f32 v30, v30
    v_mov_b32 v14, v28
    v_mul_f32 v19, v19, v29
    s_waitcnt lgkmcnt(0)
    v_fma_f32 v19, v24, v30, v19
    v_lshlrev_b32 v32, 16, v0
    v_and_b32 v33, 0xffff0000, v0
    v_lshlrev_b32 v34, 16, v1
    v_and_b32 v35, 0xffff0000, v1
    v_mul_f32 v32, v32, v30
    v_mul_f32 v33, v33, v30
    v_mul_f32 v34, v34, v30
    v_mul_f32 v35, v35, v30
    v_cvt_pk_bf16_f32 v0, v32, v33
    v_cvt_pk_bf16_f32 v1, v34, v35
    ds_write_b64 v8, v[0:1] offset:2048
    s_waitcnt lgkmcnt(0)
    ds_read_b128 v[28:31], v11 offset:512
    ds_read_b32 v2, v3 offset:512
    ds_read_b64 v[0:1], v8 offset:4096
    ds_read_b32 v25, v12 offset:512
    s_waitcnt lgkmcnt(3)
    v_max3_f32 v28, v28, v29, v30
    v_max3_f32 v28, v28, v31, v15
    s_waitcnt lgkmcnt(2)
    v_max_f32 v2, v2, v15
    v_sub_f32 v29, v15, v28
    v_sub_f32 v30, v2, v28
    v_exp_f32 v29, v29
    v_exp_f32 v30, v30
    v_mov_b32 v15, v28
    v_mul_f32 v20, v20, v29
    s_waitcnt lgkmcnt(0)
    v_fma_f32 v20, v25, v30, v20
    v_lshlrev_b32 v32, 16, v0
    v_and_b32 v33, 0xffff0000, v0
    v_lshlrev_b32 v34, 16, v1
    v_and_b32 v35, 0xffff0000, v1
    v_mul_f32 v32, v32, v30
    v_mul_f32 v33, v33, v30
    v_mul_f32 v34, v34, v30
    v_mul_f32 v35, v35, v30
    v_cvt_pk_bf16_f32 v0, v32, v33
    v_cvt_pk_bf16_f32 v1, v34, v35
    ds_write_b64 v8, v[0:1] offset:4096
    s_waitcnt lgkmcnt(0)
    ds_read_b128 v[28:31], v11 offset:768
    ds_read_b32 v2, v3 offset:768
    ds_read_b64 v[0:1], v8 offset:6144
    ds_read_b32 v26, v12 offset:768
    s_waitcnt lgkmcnt(3)
    v_max3_f32 v28, v28, v29, v30
    v_max3_f32 v28, v28, v31, v16
    s_waitcnt lgkmcnt(2)
    v_max_f32 v2, v2, v16
    v_sub_f32 v29, v16, v28
    v_sub_f32 v30, v2, v28
    v_exp_f32 v29, v29
    v_exp_f32 v30, v30
    v_mov_b32 v16, v28
    v_mul_f32 v21, v21, v29
    s_waitcnt lgkmcnt(0)
    v_fma_f32 v21, v26, v30, v21
    v_lshlrev_b32 v32, 16, v0
    v_and_b32 v33, 0xffff0000, v0
    v_lshlrev_b32 v34, 16, v1
    v_and_b32 v35, 0xffff0000, v1
    v_mul_f32 v32, v32, v30
    v_mul_f32 v33, v33, v30
    v_mul_f32 v34, v34, v30
    v_mul_f32 v35, v35, v30
    v_cvt_pk_bf16_f32 v0, v32, v33
    v_cvt_pk_bf16_f32 v1, v34, v35
    ds_write_b64 v8, v[0:1] offset:6144
    s_waitcnt lgkmcnt(0)
    s_barrier
    v_mov_b32 v28, 0xff800000
    v_mov_b32 v29, 0
    ds_write_b32 v3, v28 offset:0
    ds_write_b32 v12, v29 offset:0
    ds_write_b32 v3, v28 offset:256
    ds_write_b32 v12, v29 offset:256
    ds_write_b32 v3, v28 offset:512
    ds_write_b32 v12, v29 offset:512
    ds_write_b32 v3, v28 offset:768
    ds_write_b32 v12, v29 offset:768
    s_waitcnt lgkmcnt(0)
    v_fma_f32 v28, v44, s32, -v13
    v_fma_f32 v29, v45, s32, -v13
    v_fma_f32 v30, v46, s32, -v13
    v_fma_f32 v31, v47, s32, -v13
    v_exp_f32 v28, v28
    v_exp_f32 v29, v29
    v_exp_f32 v30, v30
    v_exp_f32 v31, v31
    v_cvt_pk_bf16_f32 v0, v28, v29
    v_add_f32 v23, v28, v29
    v_cvt_pk_bf16_f32 v1, v30, v31
    v_add_f32 v30, v30, v31
    v_add_f32 v23, v23, v30
    v_fma_f32 v32, v48, s32, -v14
    v_fma_f32 v33, v49, s32, -v14
    v_fma_f32 v34, v50, s32, -v14
    v_fma_f32 v35, v51, s32, -v14
    v_exp_f32 v32, v32
    v_exp_f32 v33, v33
    v_exp_f32 v34, v34
    v_exp_f32 v35, v35
    v_cvt_pk_bf16_f32 v2, v32, v33
    v_add_f32 v24, v32, v33
    v_cvt_pk_bf16_f32 v3, v34, v35
    v_add_f32 v34, v34, v35
    v_add_f32 v24, v24, v34
    v_fma_f32 v28, v52, s32, -v15
    v_fma_f32 v29, v53, s32, -v15
    v_fma_f32 v30, v54, s32, -v15
    v_fma_f32 v31, v55, s32, -v15
    v_exp_f32 v28, v28
    v_exp_f32 v29, v29
    v_exp_f32 v30, v30
    v_exp_f32 v31, v31
    v_cvt_pk_bf16_f32 v36, v28, v29
    v_add_f32 v25, v28, v29
    v_cvt_pk_bf16_f32 v37, v30, v31
    v_add_f32 v30, v30, v31
    v_add_f32 v25, v25, v30
    v_fma_f32 v32, v56, s32, -v16
    v_fma_f32 v33, v57, s32, -v16
    v_fma_f32 v34, v58, s32, -v16
    v_fma_f32 v35, v59, s32, -v16
    v_exp_f32 v32, v32
    v_exp_f32 v33, v33
    v_exp_f32 v34, v34
    v_exp_f32 v35, v35
    v_cvt_pk_bf16_f32 v38, v32, v33
    v_add_f32 v26, v32, v33
    v_cvt_pk_bf16_f32 v39, v34, v35
    v_add_f32 v34, v34, v35
    v_add_f32 v26, v26, v34
    s_nop 3
    s_branch L_retca11
L_slowp11:
    s_waitcnt lgkmcnt(0)
    s_nop 11
    v_mbcnt_lo_u32_b32 v11, -1, 0
    v_mbcnt_hi_u32_b32 v11, -1, v11
    v_and_b32 v11, 15, v11
    v_lshlrev_b32 v11, 4, v11
    v_add_u32 v11, 151552, v11
    s_lshl_b32 s40, s30, 2
    v_add_u32 v11, s40, v11
    v_max3_f32 v32, v44, v45, v46
    v_max_f32 v32, v32, v47
    v_mov_b32 v33, v32
    s_nop 1
    v_permlane16_swap_b32 v32, v33
    s_nop 0
    v_max_f32 v32, v32, v33
    v_mov_b32 v33, v32
    s_nop 1
    v_permlane32_swap_b32 v32, v33
    s_nop 0
    v_max_f32 v32, v32, v33
    v_mul_f32 v32, s32, v32
    v_ceil_f32 v32, v32
    v_max_f32 v32, v32, v13
    ds_write_b32 v11, v32 offset:1280
    v_fma_f32 v28, v44, s32, -v32
    v_fma_f32 v29, v45, s32, -v32
    v_fma_f32 v30, v46, s32, -v32
    v_fma_f32 v31, v47, s32, -v32
    v_exp_f32 v28, v28
    v_exp_f32 v29, v29
    v_exp_f32 v30, v30
    v_exp_f32 v31, v31
    v_cvt_pk_bf16_f32 v0, v28, v29
    v_add_f32 v23, v28, v29
    v_cvt_pk_bf16_f32 v1, v30, v31
    v_add_f32 v30, v30, v31
    v_add_f32 v23, v23, v30
    s_waitcnt lgkmcnt(0)
    v_max3_f32 v28, v48, v49, v50
    v_max_f32 v28, v28, v51
    v_mov_b32 v29, v28
    s_nop 1
    v_permlane16_swap_b32 v28, v29
    s_nop 0
    v_max_f32 v28, v28, v29
    v_mov_b32 v29, v28
    s_nop 1
    v_permlane32_swap_b32 v28, v29
    s_nop 0
    v_max_f32 v28, v28, v29
    v_mul_f32 v28, s32, v28
    v_ceil_f32 v28, v28
    v_max_f32 v28, v28, v14
    ds_write_b32 v11, v28 offset:1536
    v_fma_f32 v32, v48, s32, -v28
    v_fma_f32 v33, v49, s32, -v28
    v_fma_f32 v34, v50, s32, -v28
    v_fma_f32 v35, v51, s32, -v28
    v_exp_f32 v32, v32
    v_exp_f32 v33, v33
    v_exp_f32 v34, v34
    v_exp_f32 v35, v35
    v_cvt_pk_bf16_f32 v2, v32, v33
    v_add_f32 v24, v32, v33
    v_cvt_pk_bf16_f32 v3, v34, v35
    v_add_f32 v34, v34, v35
    v_add_f32 v24, v24, v34
    s_waitcnt lgkmcnt(0)
    v_max3_f32 v32, v52, v53, v54
    v_max_f32 v32, v32, v55
    v_mov_b32 v33, v32
    s_nop 1
    v_permlane16_swap_b32 v32, v33
    s_nop 0
    v_max_f32 v32, v32, v33
    v_mov_b32 v33, v32
    s_nop 1
    v_permlane32_swap_b32 v32, v33
    s_nop 0
    v_max_f32 v32, v32, v33
    v_mul_f32 v32, s32, v32
    v_ceil_f32 v32, v32
    v_max_f32 v32, v32, v15
    ds_write_b32 v11, v32 offset:1792
    v_fma_f32 v28, v52, s32, -v32
    v_fma_f32 v29, v53, s32, -v32
    v_fma_f32 v30, v54, s32, -v32
    v_fma_f32 v31, v55, s32, -v32
    v_exp_f32 v28, v28
    v_exp_f32 v29, v29
    v_exp_f32 v30, v30
    v_exp_f32 v31, v31
    v_cvt_pk_bf16_f32 v36, v28, v29
    v_add_f32 v25, v28, v29
    v_cvt_pk_bf16_f32 v37, v30, v31
    v_add_f32 v30, v30, v31
    v_add_f32 v25, v25, v30
    s_waitcnt lgkmcnt(0)
    v_max3_f32 v28, v56, v57, v58
    v_max_f32 v28, v28, v59
    v_mov_b32 v29, v28
    s_nop 1
    v_permlane16_swap_b32 v28, v29
    s_nop 0
    v_max_f32 v28, v28, v29
    v_mov_b32 v29, v28
    s_nop 1
    v_permlane32_swap_b32 v28, v29
    s_nop 0
    v_max_f32 v28, v28, v29
    v_mul_f32 v28, s32, v28
    v_ceil_f32 v28, v28
    v_max_f32 v28, v28, v16
    ds_write_b32 v11, v28 offset:2048
    v_fma_f32 v32, v56, s32, -v28
    v_fma_f32 v33, v57, s32, -v28
    v_fma_f32 v34, v58, s32, -v28
    v_fma_f32 v35, v59, s32, -v28
    v_exp_f32 v32, v32
    v_exp_f32 v33, v33
    v_exp_f32 v34, v34
    v_exp_f32 v35, v35
    v_cvt_pk_bf16_f32 v38, v32, v33
    v_add_f32 v26, v32, v33
    v_cvt_pk_bf16_f32 v39, v34, v35
    v_add_f32 v34, v34, v35
    v_add_f32 v26, v26, v34
    s_waitcnt lgkmcnt(0)
    v_mbcnt_lo_u32_b32 v11, -1, 0
    v_mbcnt_hi_u32_b32 v11, -1, v11
    v_lshlrev_b32 v11, 2, v11
    s_mul_i32 s40, s30, 1280
    s_add_u32 s40, s40, 155648
    v_add_u32 v11, s40, v11
    ds_write_b32 v11, v23 offset:0
    v_mov_b32 v23, 0
    ds_write_b32 v11, v24 offset:256
    v_mov_b32 v24, 0
    ds_write_b32 v11, v25 offset:512
    v_mov_b32 v25, 0
    ds_write_b32 v11, v26 offset:768
    v_mov_b32 v26, 0
    s_waitcnt lgkmcnt(0)
    v_or_b32 v12, 0x10000, v12
    s_nop 3
    s_branch L_retp11
L_slowca12:
    v_and_b32 v12, 0xffff, v11
    v_cmp_ne_u32 vcc, s39, v12
    s_cbranch_vccz L_slowca12_ready
    s_sleep 1
    ds_read_b32 v11, v9 offset:32
    s_waitcnt lgkmcnt(0)
    v_cmp_ne_u32 vcc, s39, v11
    s_cbranch_vccz L_retca12
    s_branch L_slowca12
L_slowca12_ready:
    s_waitcnt lgkmcnt(0)
    s_nop 11
    v_mbcnt_lo_u32_b32 v11, -1, 0
    v_mbcnt_hi_u32_b32 v11, -1, v11
    v_and_b32 v11, 15, v11
    v_lshlrev_b32 v11, 4, v11
    v_add_u32 v11, 151552, v11
    s_lshl_b32 s40, s30, 2
    v_add_u32 v3, s40, v11
    v_mbcnt_lo_u32_b32 v12, -1, 0
    v_mbcnt_hi_u32_b32 v12, -1, v12
    v_lshlrev_b32 v12, 2, v12
    s_mul_i32 s40, s30, 1280
    s_add_u32 s40, s40, 155648
    v_add_u32 v12, s40, v12
    ds_read_b128 v[28:31], v11 offset:1280
    ds_read_b32 v2, v3 offset:1280
    ds_read_b64 v[0:1], v8 offset:10240
    ds_read_b32 v23, v12 offset:0
    s_waitcnt lgkmcnt(3)
    v_max3_f32 v28, v28, v29, v30
    v_max3_f32 v28, v28, v31, v13
    s_waitcnt lgkmcnt(2)
    v_max_f32 v2, v2, v13
    v_sub_f32 v29, v13, v28
    v_sub_f32 v30, v2, v28
    v_exp_f32 v29, v29
    v_exp_f32 v30, v30
    v_mov_b32 v13, v28
    v_mul_f32 v18, v18, v29
    s_waitcnt lgkmcnt(0)
    v_fma_f32 v18, v23, v30, v18
    v_lshlrev_b32 v32, 16, v0
    v_and_b32 v33, 0xffff0000, v0
    v_lshlrev_b32 v34, 16, v1
    v_and_b32 v35, 0xffff0000, v1
    v_mul_f32 v32, v32, v30
    v_mul_f32 v33, v33, v30
    v_mul_f32 v34, v34, v30
    v_mul_f32 v35, v35, v30
    v_cvt_pk_bf16_f32 v0, v32, v33
    v_cvt_pk_bf16_f32 v1, v34, v35
    ds_write_b64 v8, v[0:1] offset:10240
    s_waitcnt lgkmcnt(0)
    ds_read_b128 v[28:31], v11 offset:1536
    ds_read_b32 v2, v3 offset:1536
    ds_read_b64 v[0:1], v8 offset:12288
    ds_read_b32 v24, v12 offset:256
    s_waitcnt lgkmcnt(3)
    v_max3_f32 v28, v28, v29, v30
    v_max3_f32 v28, v28, v31, v14
    s_waitcnt lgkmcnt(2)
    v_max_f32 v2, v2, v14
    v_sub_f32 v29, v14, v28
    v_sub_f32 v30, v2, v28
    v_exp_f32 v29, v29
    v_exp_f32 v30, v30
    v_mov_b32 v14, v28
    v_mul_f32 v19, v19, v29
    s_waitcnt lgkmcnt(0)
    v_fma_f32 v19, v24, v30, v19
    v_lshlrev_b32 v32, 16, v0
    v_and_b32 v33, 0xffff0000, v0
    v_lshlrev_b32 v34, 16, v1
    v_and_b32 v35, 0xffff0000, v1
    v_mul_f32 v32, v32, v30
    v_mul_f32 v33, v33, v30
    v_mul_f32 v34, v34, v30
    v_mul_f32 v35, v35, v30
    v_cvt_pk_bf16_f32 v0, v32, v33
    v_cvt_pk_bf16_f32 v1, v34, v35
    ds_write_b64 v8, v[0:1] offset:12288
    s_waitcnt lgkmcnt(0)
    ds_read_b128 v[28:31], v11 offset:1792
    ds_read_b32 v2, v3 offset:1792
    ds_read_b64 v[0:1], v8 offset:14336
    ds_read_b32 v25, v12 offset:512
    s_waitcnt lgkmcnt(3)
    v_max3_f32 v28, v28, v29, v30
    v_max3_f32 v28, v28, v31, v15
    s_waitcnt lgkmcnt(2)
    v_max_f32 v2, v2, v15
    v_sub_f32 v29, v15, v28
    v_sub_f32 v30, v2, v28
    v_exp_f32 v29, v29
    v_exp_f32 v30, v30
    v_mov_b32 v15, v28
    v_mul_f32 v20, v20, v29
    s_waitcnt lgkmcnt(0)
    v_fma_f32 v20, v25, v30, v20
    v_lshlrev_b32 v32, 16, v0
    v_and_b32 v33, 0xffff0000, v0
    v_lshlrev_b32 v34, 16, v1
    v_and_b32 v35, 0xffff0000, v1
    v_mul_f32 v32, v32, v30
    v_mul_f32 v33, v33, v30
    v_mul_f32 v34, v34, v30
    v_mul_f32 v35, v35, v30
    v_cvt_pk_bf16_f32 v0, v32, v33
    v_cvt_pk_bf16_f32 v1, v34, v35
    ds_write_b64 v8, v[0:1] offset:14336
    s_waitcnt lgkmcnt(0)
    ds_read_b128 v[28:31], v11 offset:2048
    ds_read_b32 v2, v3 offset:2048
    ds_read_b64 v[0:1], v8 offset:16384
    ds_read_b32 v26, v12 offset:768
    s_waitcnt lgkmcnt(3)
    v_max3_f32 v28, v28, v29, v30
    v_max3_f32 v28, v28, v31, v16
    s_waitcnt lgkmcnt(2)
    v_max_f32 v2, v2, v16
    v_sub_f32 v29, v16, v28
    v_sub_f32 v30, v2, v28
    v_exp_f32 v29, v29
    v_exp_f32 v30, v30
    v_mov_b32 v16, v28
    v_mul_f32 v21, v21, v29
    s_waitcnt lgkmcnt(0)
    v_fma_f32 v21, v26, v30, v21
    v_lshlrev_b32 v32, 16, v0
    v_and_b32 v33, 0xffff0000, v0
    v_lshlrev_b32 v34, 16, v1
    v_and_b32 v35, 0xffff0000, v1
    v_mul_f32 v32, v32, v30
    v_mul_f32 v33, v33, v30
    v_mul_f32 v34, v34, v30
    v_mul_f32 v35, v35, v30
    v_cvt_pk_bf16_f32 v0, v32, v33
    v_cvt_pk_bf16_f32 v1, v34, v35
    ds_write_b64 v8, v[0:1] offset:16384
    s_waitcnt lgkmcnt(0)
    s_barrier
    v_mov_b32 v28, 0xff800000
    v_mov_b32 v29, 0
    ds_write_b32 v3, v28 offset:1280
    ds_write_b32 v12, v29 offset:0
    ds_write_b32 v3, v28 offset:1536
    ds_write_b32 v12, v29 offset:256
    ds_write_b32 v3, v28 offset:1792
    ds_write_b32 v12, v29 offset:512
    ds_write_b32 v3, v28 offset:2048
    ds_write_b32 v12, v29 offset:768
    s_waitcnt lgkmcnt(0)
    s_nop 3
    s_branch L_retca12
L_slowcb13:
    v_and_b32 v25, 0xffff, v17
    v_cmp_ne_u32 vcc, s39, v25
    s_cbranch_vccz L_slowcb13_ready
    s_sleep 1
    ds_read_b32 v17, v14 offset:0
    s_waitcnt lgkmcnt(0)
    v_cmp_ne_u32 vcc, s39, v17
    s_cbranch_vccz L_retcb13
    s_branch L_slowcb13
L_slowcb13_ready:
    s_waitcnt lgkmcnt(0)
    s_nop 11
    s_nop 7
    ds_read_b128 v[28:31], v19 offset:0
    s_waitcnt lgkmcnt(0)
    v_max3_f32 v28, v28, v29, v30
    v_max3_f32 v28, v28, v31, v20
    v_sub_f32 v29, v20, v28
    v_exp_f32 v29, v29
    v_mov_b32 v20, v28
    v_mul_f32 v48, v48, v29
    v_mul_f32 v49, v49, v29
    v_mul_f32 v50, v50, v29
    v_mul_f32 v51, v51, v29
    v_mul_f32 v52, v52, v29
    v_mul_f32 v53, v53, v29
    v_mul_f32 v54, v54, v29
    v_mul_f32 v55, v55, v29
    v_mul_f32 v56, v56, v29
    v_mul_f32 v57, v57, v29
    v_mul_f32 v58, v58, v29
    v_mul_f32 v59, v59, v29
    v_mul_f32 v60, v60, v29
    v_mul_f32 v61, v61, v29
    v_mul_f32 v62, v62, v29
    v_mul_f32 v63, v63, v29
    ds_read_b128 v[28:31], v19 offset:256
    s_waitcnt lgkmcnt(0)
    v_max3_f32 v28, v28, v29, v30
    v_max3_f32 v28, v28, v31, v21
    v_sub_f32 v29, v21, v28
    v_exp_f32 v29, v29
    v_mov_b32 v21, v28
    v_mul_f32 v64, v64, v29
    v_mul_f32 v65, v65, v29
    v_mul_f32 v66, v66, v29
    v_mul_f32 v67, v67, v29
    v_mul_f32 v68, v68, v29
    v_mul_f32 v69, v69, v29
    v_mul_f32 v70, v70, v29
    v_mul_f32 v71, v71, v29
    v_mul_f32 v72, v72, v29
    v_mul_f32 v73, v73, v29
    v_mul_f32 v74, v74, v29
    v_mul_f32 v75, v75, v29
    v_mul_f32 v76, v76, v29
    v_mul_f32 v77, v77, v29
    v_mul_f32 v78, v78, v29
    v_mul_f32 v79, v79, v29
    ds_read_b128 v[28:31], v19 offset:512
    s_waitcnt lgkmcnt(0)
    v_max3_f32 v28, v28, v29, v30
    v_max3_f32 v28, v28, v31, v22
    v_sub_f32 v29, v22, v28
    v_exp_f32 v29, v29
    v_mov_b32 v22, v28
    v_mul_f32 v80, v80, v29
    v_mul_f32 v81, v81, v29
    v_mul_f32 v82, v82, v29
    v_mul_f32 v83, v83, v29
    v_mul_f32 v84, v84, v29
    v_mul_f32 v85, v85, v29
    v_mul_f32 v86, v86, v29
    v_mul_f32 v87, v87, v29
    v_mul_f32 v88, v88, v29
    v_mul_f32 v89, v89, v29
    v_mul_f32 v90, v90, v29
    v_mul_f32 v91, v91, v29
    v_mul_f32 v92, v92, v29
    v_mul_f32 v93, v93, v29
    v_mul_f32 v94, v94, v29
    v_mul_f32 v95, v95, v29
    ds_read_b128 v[28:31], v19 offset:768
    s_waitcnt lgkmcnt(0)
    v_max3_f32 v28, v28, v29, v30
    v_max3_f32 v28, v28, v31, v23
    v_sub_f32 v29, v23, v28
    v_exp_f32 v29, v29
    v_mov_b32 v23, v28
    v_mul_f32 v96, v96, v29
    v_mul_f32 v97, v97, v29
    v_mul_f32 v98, v98, v29
    v_mul_f32 v99, v99, v29
    v_mul_f32 v100, v100, v29
    v_mul_f32 v101, v101, v29
    v_mul_f32 v102, v102, v29
    v_mul_f32 v103, v103, v29
    v_mul_f32 v104, v104, v29
    v_mul_f32 v105, v105, v29
    v_mul_f32 v106, v106, v29
    v_mul_f32 v107, v107, v29
    v_mul_f32 v108, v108, v29
    v_mul_f32 v109, v109, v29
    v_mul_f32 v110, v110, v29
    v_mul_f32 v111, v111, v29
    ds_read_b128 v[28:31], v19 offset:1024
    s_waitcnt lgkmcnt(0)
    v_max3_f32 v28, v28, v29, v30
    v_max3_f32 v28, v28, v31, v24
    v_sub_f32 v29, v24, v28
    v_exp_f32 v29, v29
    v_mov_b32 v24, v28
    v_mul_f32 v112, v112, v29
    v_mul_f32 v113, v113, v29
    v_mul_f32 v114, v114, v29
    v_mul_f32 v115, v115, v29
    v_mul_f32 v116, v116, v29
    v_mul_f32 v117, v117, v29
    v_mul_f32 v118, v118, v29
    v_mul_f32 v119, v119, v29
    v_mul_f32 v120, v120, v29
    v_mul_f32 v121, v121, v29
    v_mul_f32 v122, v122, v29
    v_mul_f32 v123, v123, v29
    v_mul_f32 v124, v124, v29
    v_mul_f32 v125, v125, v29
    v_mul_f32 v126, v126, v29
    v_mul_f32 v127, v127, v29
    s_waitcnt lgkmcnt(0)
    s_barrier
    s_nop 3
    s_branch L_retcb13
L_slowcb16:
    v_and_b32 v25, 0xffff, v17
    v_cmp_ne_u32 vcc, s39, v25
    s_cbranch_vccz L_slowcb16_ready
    s_sleep 1
    ds_read_b32 v17, v14 offset:32
    s_waitcnt lgkmcnt(0)
    v_cmp_ne_u32 vcc, s39, v17
    s_cbranch_vccz L_retcb16
    s_branch L_slowcb16
L_slowcb16_ready:
    s_waitcnt lgkmcnt(0)
    s_nop 11
    v_mfma_f32_16x16x32_bf16 v[96:99], a[0:3], a[88:91], v[96:99]
    v_mfma_f32_16x16x32_bf16 v[100:103], a[4:7], a[88:91], v[100:103]
    v_mfma_f32_16x16x32_bf16 v[104:107], a[8:11], a[88:91], v[104:107]
    v_mfma_f32_16x16x32_bf16 v[108:111], a[12:15], a[88:91], v[108:111]
    v_mfma_f32_16x16x32_bf16 v[96:99], a[16:19], a[92:95], v[96:99]
    v_mfma_f32_16x16x32_bf16 v[100:103], a[20:23], a[92:95], v[100:103]
    v_mfma_f32_16x16x32_bf16 v[104:107], a[24:27], a[92:95], v[104:107]
    v_mfma_f32_16x16x32_bf16 v[108:111], a[28:31], a[92:95], v[108:111]
    v_mfma_f32_16x16x32_bf16 v[112:115], a[0:3], a[96:99], v[112:115]
    v_mfma_f32_16x16x32_bf16 v[116:119], a[4:7], a[96:99], v[116:119]
    v_mfma_f32_16x16x32_bf16 v[120:123], a[8:11], a[96:99], v[120:123]
    v_mfma_f32_16x16x32_bf16 v[124:127], a[12:15], a[96:99], v[124:127]
    v_mfma_f32_16x16x32_bf16 v[112:115], a[16:19], a[100:103], v[112:115]
    v_mfma_f32_16x16x32_bf16 v[116:119], a[20:23], a[100:103], v[116:119]
    v_mfma_f32_16x16x32_bf16 v[120:123], a[24:27], a[100:103], v[120:123]
    v_mfma_f32_16x16x32_bf16 v[124:127], a[28:31], a[100:103], v[124:127]
    s_nop 7
    v_accvgpr_write_b32 a88, 0
    v_accvgpr_write_b32 a89, 0
    v_accvgpr_write_b32 a90, 0
    v_accvgpr_write_b32 a91, 0
    v_accvgpr_write_b32 a92, 0
    v_accvgpr_write_b32 a93, 0
    v_accvgpr_write_b32 a94, 0
    v_accvgpr_write_b32 a95, 0
    v_accvgpr_write_b32 a96, 0
    v_accvgpr_write_b32 a97, 0
    v_accvgpr_write_b32 a98, 0
    v_accvgpr_write_b32 a99, 0
    v_accvgpr_write_b32 a100, 0
    v_accvgpr_write_b32 a101, 0
    v_accvgpr_write_b32 a102, 0
    v_accvgpr_write_b32 a103, 0
    ds_read_b128 v[28:31], v19 offset:1280
    s_waitcnt lgkmcnt(0)
    v_max3_f32 v28, v28, v29, v30
    v_max3_f32 v28, v28, v31, v20
    v_sub_f32 v29, v20, v28
    v_exp_f32 v29, v29
    v_mov_b32 v20, v28
    v_mul_f32 v48, v48, v29
    v_mul_f32 v49, v49, v29
    v_mul_f32 v50, v50, v29
    v_mul_f32 v51, v51, v29
    v_mul_f32 v52, v52, v29
    v_mul_f32 v53, v53, v29
    v_mul_f32 v54, v54, v29
    v_mul_f32 v55, v55, v29
    v_mul_f32 v56, v56, v29
    v_mul_f32 v57, v57, v29
    v_mul_f32 v58, v58, v29
    v_mul_f32 v59, v59, v29
    v_mul_f32 v60, v60, v29
    v_mul_f32 v61, v61, v29
    v_mul_f32 v62, v62, v29
    v_mul_f32 v63, v63, v29
    ds_read_b128 v[28:31], v19 offset:1536
    s_waitcnt lgkmcnt(0)
    v_max3_f32 v28, v28, v29, v30
    v_max3_f32 v28, v28, v31, v21
    v_sub_f32 v29, v21, v28
    v_exp_f32 v29, v29
    v_mov_b32 v21, v28
    v_mul_f32 v64, v64, v29
    v_mul_f32 v65, v65, v29
    v_mul_f32 v66, v66, v29
    v_mul_f32 v67, v67, v29
    v_mul_f32 v68, v68, v29
    v_mul_f32 v69, v69, v29
    v_mul_f32 v70, v70, v29
    v_mul_f32 v71, v71, v29
    v_mul_f32 v72, v72, v29
    v_mul_f32 v73, v73, v29
    v_mul_f32 v74, v74, v29
    v_mul_f32 v75, v75, v29
    v_mul_f32 v76, v76, v29
    v_mul_f32 v77, v77, v29
    v_mul_f32 v78, v78, v29
    v_mul_f32 v79, v79, v29
    ds_read_b128 v[28:31], v19 offset:1792
    s_waitcnt lgkmcnt(0)
    v_max3_f32 v28, v28, v29, v30
    v_max3_f32 v28, v28, v31, v22
    v_sub_f32 v29, v22, v28
    v_exp_f32 v29, v29
    v_mov_b32 v22, v28
    v_mul_f32 v80, v80, v29
    v_mul_f32 v81, v81, v29
    v_mul_f32 v82, v82, v29
    v_mul_f32 v83, v83, v29
    v_mul_f32 v84, v84, v29
    v_mul_f32 v85, v85, v29
    v_mul_f32 v86, v86, v29
    v_mul_f32 v87, v87, v29
    v_mul_f32 v88, v88, v29
    v_mul_f32 v89, v89, v29
    v_mul_f32 v90, v90, v29
    v_mul_f32 v91, v91, v29
    v_mul_f32 v92, v92, v29
    v_mul_f32 v93, v93, v29
    v_mul_f32 v94, v94, v29
    v_mul_f32 v95, v95, v29
    ds_read_b128 v[28:31], v19 offset:2048
    s_waitcnt lgkmcnt(0)
    v_max3_f32 v28, v28, v29, v30
    v_max3_f32 v28, v28, v31, v23
    v_sub_f32 v29, v23, v28
    v_exp_f32 v29, v29
    v_mov_b32 v23, v28
    v_mul_f32 v96, v96, v29
    v_mul_f32 v97, v97, v29
    v_mul_f32 v98, v98, v29
    v_mul_f32 v99, v99, v29
    v_mul_f32 v100, v100, v29
    v_mul_f32 v101, v101, v29
    v_mul_f32 v102, v102, v29
    v_mul_f32 v103, v103, v29
    v_mul_f32 v104, v104, v29
    v_mul_f32 v105, v105, v29
    v_mul_f32 v106, v106, v29
    v_mul_f32 v107, v107, v29
    v_mul_f32 v108, v108, v29
    v_mul_f32 v109, v109, v29
    v_mul_f32 v110, v110, v29
    v_mul_f32 v111, v111, v29
    ds_read_b128 v[28:31], v19 offset:2304
    s_waitcnt lgkmcnt(0)
    v_max3_f32 v28, v28, v29, v30
    v_max3_f32 v28, v28, v31, v24
    v_sub_f32 v29, v24, v28
    v_exp_f32 v29, v29
    v_mov_b32 v24, v28
    v_mul_f32 v112, v112, v29
    v_mul_f32 v113, v113, v29
    v_mul_f32 v114, v114, v29
    v_mul_f32 v115, v115, v29
    v_mul_f32 v116, v116, v29
    v_mul_f32 v117, v117, v29
    v_mul_f32 v118, v118, v29
    v_mul_f32 v119, v119, v29
    v_mul_f32 v120, v120, v29
    v_mul_f32 v121, v121, v29
    v_mul_f32 v122, v122, v29
    v_mul_f32 v123, v123, v29
    v_mul_f32 v124, v124, v29
    v_mul_f32 v125, v125, v29
    v_mul_f32 v126, v126, v29
    v_mul_f32 v127, v127, v29
    s_waitcnt lgkmcnt(0)
    s_barrier
    s_nop 3
    s_branch L_retcb16
L_slowcb17:
    v_and_b32 v25, 0xffff, v17
    v_cmp_ne_u32 vcc, s39, v25
    s_cbranch_vccz L_slowcb17_ready
    s_sleep 1
    ds_read_b32 v17, v14 offset:0
    s_waitcnt lgkmcnt(0)
    v_cmp_ne_u32 vcc, s39, v17
    s_cbranch_vccz L_retcb17
    s_branch L_slowcb17
L_slowcb17_ready:
    s_waitcnt lgkmcnt(0)
    s_nop 11
    v_mfma_f32_16x16x32_bf16 v[96:99], a[32:35], a[88:91], v[96:99]
    v_mfma_f32_16x16x32_bf16 v[100:103], a[36:39], a[88:91], v[100:103]
    v_mfma_f32_16x16x32_bf16 v[104:107], a[40:43], a[88:91], v[104:107]
    v_mfma_f32_16x16x32_bf16 v[108:111], a[44:47], a[88:91], v[108:111]
    v_mfma_f32_16x16x32_bf16 v[96:99], a[48:51], a[92:95], v[96:99]
    v_mfma_f32_16x16x32_bf16 v[100:103], a[52:55], a[92:95], v[100:103]
    v_mfma_f32_16x16x32_bf16 v[104:107], a[56:59], a[92:95], v[104:107]
    v_mfma_f32_16x16x32_bf16 v[108:111], a[60:63], a[92:95], v[108:111]
    v_mfma_f32_16x16x32_bf16 v[112:115], a[32:35], a[96:99], v[112:115]
    v_mfma_f32_16x16x32_bf16 v[116:119], a[36:39], a[96:99], v[116:119]
    v_mfma_f32_16x16x32_bf16 v[120:123], a[40:43], a[96:99], v[120:123]
    v_mfma_f32_16x16x32_bf16 v[124:127], a[44:47], a[96:99], v[124:127]
    v_mfma_f32_16x16x32_bf16 v[112:115], a[48:51], a[100:103], v[112:115]
    v_mfma_f32_16x16x32_bf16 v[116:119], a[52:55], a[100:103], v[116:119]
    v_mfma_f32_16x16x32_bf16 v[120:123], a[56:59], a[100:103], v[120:123]
    v_mfma_f32_16x16x32_bf16 v[124:127], a[60:63], a[100:103], v[124:127]
    s_nop 7
    v_accvgpr_write_b32 a88, 0
    v_accvgpr_write_b32 a89, 0
    v_accvgpr_write_b32 a90, 0
    v_accvgpr_write_b32 a91, 0
    v_accvgpr_write_b32 a92, 0
    v_accvgpr_write_b32 a93, 0
    v_accvgpr_write_b32 a94, 0
    v_accvgpr_write_b32 a95, 0
    v_accvgpr_write_b32 a96, 0
    v_accvgpr_write_b32 a97, 0
    v_accvgpr_write_b32 a98, 0
    v_accvgpr_write_b32 a99, 0
    v_accvgpr_write_b32 a100, 0
    v_accvgpr_write_b32 a101, 0
    v_accvgpr_write_b32 a102, 0
    v_accvgpr_write_b32 a103, 0
    ds_read_b128 v[28:31], v19 offset:0
    s_waitcnt lgkmcnt(0)
    v_max3_f32 v28, v28, v29, v30
    v_max3_f32 v28, v28, v31, v20
    v_sub_f32 v29, v20, v28
    v_exp_f32 v29, v29
    v_mov_b32 v20, v28
    v_mul_f32 v48, v48, v29
    v_mul_f32 v49, v49, v29
    v_mul_f32 v50, v50, v29
    v_mul_f32 v51, v51, v29
    v_mul_f32 v52, v52, v29
    v_mul_f32 v53, v53, v29
    v_mul_f32 v54, v54, v29
    v_mul_f32 v55, v55, v29
    v_mul_f32 v56, v56, v29
    v_mul_f32 v57, v57, v29
    v_mul_f32 v58, v58, v29
    v_mul_f32 v59, v59, v29
    v_mul_f32 v60, v60, v29
    v_mul_f32 v61, v61, v29
    v_mul_f32 v62, v62, v29
    v_mul_f32 v63, v63, v29
    ds_read_b128 v[28:31], v19 offset:256
    s_waitcnt lgkmcnt(0)
    v_max3_f32 v28, v28, v29, v30
    v_max3_f32 v28, v28, v31, v21
    v_sub_f32 v29, v21, v28
    v_exp_f32 v29, v29
    v_mov_b32 v21, v28
    v_mul_f32 v64, v64, v29
    v_mul_f32 v65, v65, v29
    v_mul_f32 v66, v66, v29
    v_mul_f32 v67, v67, v29
    v_mul_f32 v68, v68, v29
    v_mul_f32 v69, v69, v29
    v_mul_f32 v70, v70, v29
    v_mul_f32 v71, v71, v29
    v_mul_f32 v72, v72, v29
    v_mul_f32 v73, v73, v29
    v_mul_f32 v74, v74, v29
    v_mul_f32 v75, v75, v29
    v_mul_f32 v76, v76, v29
    v_mul_f32 v77, v77, v29
    v_mul_f32 v78, v78, v29
    v_mul_f32 v79, v79, v29
    ds_read_b128 v[28:31], v19 offset:512
    s_waitcnt lgkmcnt(0)
    v_max3_f32 v28, v28, v29, v30
    v_max3_f32 v28, v28, v31, v22
    v_sub_f32 v29, v22, v28
    v_exp_f32 v29, v29
    v_mov_b32 v22, v28
    v_mul_f32 v80, v80, v29
    v_mul_f32 v81, v81, v29
    v_mul_f32 v82, v82, v29
    v_mul_f32 v83, v83, v29
    v_mul_f32 v84, v84, v29
    v_mul_f32 v85, v85, v29
    v_mul_f32 v86, v86, v29
    v_mul_f32 v87, v87, v29
    v_mul_f32 v88, v88, v29
    v_mul_f32 v89, v89, v29
    v_mul_f32 v90, v90, v29
    v_mul_f32 v91, v91, v29
    v_mul_f32 v92, v92, v29
    v_mul_f32 v93, v93, v29
    v_mul_f32 v94, v94, v29
    v_mul_f32 v95, v95, v29
    ds_read_b128 v[28:31], v19 offset:768
    s_waitcnt lgkmcnt(0)
    v_max3_f32 v28, v28, v29, v30
    v_max3_f32 v28, v28, v31, v23
    v_sub_f32 v29, v23, v28
    v_exp_f32 v29, v29
    v_mov_b32 v23, v28
    v_mul_f32 v96, v96, v29
    v_mul_f32 v97, v97, v29
    v_mul_f32 v98, v98, v29
    v_mul_f32 v99, v99, v29
    v_mul_f32 v100, v100, v29
    v_mul_f32 v101, v101, v29
    v_mul_f32 v102, v102, v29
    v_mul_f32 v103, v103, v29
    v_mul_f32 v104, v104, v29
    v_mul_f32 v105, v105, v29
    v_mul_f32 v106, v106, v29
    v_mul_f32 v107, v107, v29
    v_mul_f32 v108, v108, v29
    v_mul_f32 v109, v109, v29
    v_mul_f32 v110, v110, v29
    v_mul_f32 v111, v111, v29
    ds_read_b128 v[28:31], v19 offset:1024
    s_waitcnt lgkmcnt(0)
    v_max3_f32 v28, v28, v29, v30
    v_max3_f32 v28, v28, v31, v24
    v_sub_f32 v29, v24, v28
    v_exp_f32 v29, v29
    v_mov_b32 v24, v28
    v_mul_f32 v112, v112, v29
    v_mul_f32 v113, v113, v29
    v_mul_f32 v114, v114, v29
    v_mul_f32 v115, v115, v29
    v_mul_f32 v116, v116, v29
    v_mul_f32 v117, v117, v29
    v_mul_f32 v118, v118, v29
    v_mul_f32 v119, v119, v29
    v_mul_f32 v120, v120, v29
    v_mul_f32 v121, v121, v29
    v_mul_f32 v122, v122, v29
    v_mul_f32 v123, v123, v29
    v_mul_f32 v124, v124, v29
    v_mul_f32 v125, v125, v29
    v_mul_f32 v126, v126, v29
    v_mul_f32 v127, v127, v29
    s_waitcnt lgkmcnt(0)
    s_barrier
    s_nop 3
    s_branch L_retcb17
L_slowcb19:
    v_and_b32 v25, 0xffff, v17
    v_cmp_ne_u32 vcc, s39, v25
    s_cbranch_vccz L_slowcb19_ready
    s_sleep 1
    ds_read_b32 v17, v14 offset:0
    s_waitcnt lgkmcnt(0)
    v_cmp_ne_u32 vcc, s39, v17
    s_cbranch_vccz L_retcb19
    s_branch L_slowcb19
L_slowcb19_ready:
    s_waitcnt lgkmcnt(0)
    s_nop 11
    s_nop 7
    ds_read_b128 v[28:31], v19 offset:0
    s_waitcnt lgkmcnt(0)
    v_max3_f32 v28, v28, v29, v30
    v_max3_f32 v28, v28, v31, v20
    v_sub_f32 v29, v20, v28
    v_exp_f32 v29, v29
    v_mov_b32 v20, v28
    v_mul_f32 v48, v48, v29
    v_mul_f32 v49, v49, v29
    v_mul_f32 v50, v50, v29
    v_mul_f32 v51, v51, v29
    v_mul_f32 v52, v52, v29
    v_mul_f32 v53, v53, v29
    v_mul_f32 v54, v54, v29
    v_mul_f32 v55, v55, v29
    v_mul_f32 v56, v56, v29
    v_mul_f32 v57, v57, v29
    v_mul_f32 v58, v58, v29
    v_mul_f32 v59, v59, v29
    v_mul_f32 v60, v60, v29
    v_mul_f32 v61, v61, v29
    v_mul_f32 v62, v62, v29
    v_mul_f32 v63, v63, v29
    ds_read_b128 v[28:31], v19 offset:256
    s_waitcnt lgkmcnt(0)
    v_max3_f32 v28, v28, v29, v30
    v_max3_f32 v28, v28, v31, v21
    v_sub_f32 v29, v21, v28
    v_exp_f32 v29, v29
    v_mov_b32 v21, v28
    v_mul_f32 v64, v64, v29
    v_mul_f32 v65, v65, v29
    v_mul_f32 v66, v66, v29
    v_mul_f32 v67, v67, v29
    v_mul_f32 v68, v68, v29
    v_mul_f32 v69, v69, v29
    v_mul_f32 v70, v70, v29
    v_mul_f32 v71, v71, v29
    v_mul_f32 v72, v72, v29
    v_mul_f32 v73, v73, v29
    v_mul_f32 v74, v74, v29
    v_mul_f32 v75, v75, v29
    v_mul_f32 v76, v76, v29
    v_mul_f32 v77, v77, v29
    v_mul_f32 v78, v78, v29
    v_mul_f32 v79, v79, v29
    ds_read_b128 v[28:31], v19 offset:512
    s_waitcnt lgkmcnt(0)
    v_max3_f32 v28, v28, v29, v30
    v_max3_f32 v28, v28, v31, v22
    v_sub_f32 v29, v22, v28
    v_exp_f32 v29, v29
    v_mov_b32 v22, v28
    v_mul_f32 v80, v80, v29
    v_mul_f32 v81, v81, v29
    v_mul_f32 v82, v82, v29
    v_mul_f32 v83, v83, v29
    v_mul_f32 v84, v84, v29
    v_mul_f32 v85, v85, v29
    v_mul_f32 v86, v86, v29
    v_mul_f32 v87, v87, v29
    v_mul_f32 v88, v88, v29
    v_mul_f32 v89, v89, v29
    v_mul_f32 v90, v90, v29
    v_mul_f32 v91, v91, v29
    v_mul_f32 v92, v92, v29
    v_mul_f32 v93, v93, v29
    v_mul_f32 v94, v94, v29
    v_mul_f32 v95, v95, v29
    ds_read_b128 v[28:31], v19 offset:768
    s_waitcnt lgkmcnt(0)
    v_max3_f32 v28, v28, v29, v30
    v_max3_f32 v28, v28, v31, v23
    v_sub_f32 v29, v23, v28
    v_exp_f32 v29, v29
    v_mov_b32 v23, v28
    v_mul_f32 v96, v96, v29
    v_mul_f32 v97, v97, v29
    v_mul_f32 v98, v98, v29
    v_mul_f32 v99, v99, v29
    v_mul_f32 v100, v100, v29
    v_mul_f32 v101, v101, v29
    v_mul_f32 v102, v102, v29
    v_mul_f32 v103, v103, v29
    v_mul_f32 v104, v104, v29
    v_mul_f32 v105, v105, v29
    v_mul_f32 v106, v106, v29
    v_mul_f32 v107, v107, v29
    v_mul_f32 v108, v108, v29
    v_mul_f32 v109, v109, v29
    v_mul_f32 v110, v110, v29
    v_mul_f32 v111, v111, v29
    s_waitcnt lgkmcnt(0)
    s_barrier
    s_nop 3
    s_branch L_retcb19
L_slowcb22:
    v_and_b32 v25, 0xffff, v17
    v_cmp_ne_u32 vcc, s39, v25
    s_cbranch_vccz L_slowcb22_ready
    s_sleep 1
    ds_read_b32 v17, v14 offset:32
    s_waitcnt lgkmcnt(0)
    v_cmp_ne_u32 vcc, s39, v17
    s_cbranch_vccz L_retcb22
    s_branch L_slowcb22
L_slowcb22_ready:
    s_waitcnt lgkmcnt(0)
    s_nop 11
    v_mfma_f32_16x16x32_bf16 v[80:83], a[0:3], a[80:83], v[80:83]
    v_mfma_f32_16x16x32_bf16 v[84:87], a[4:7], a[80:83], v[84:87]
    v_mfma_f32_16x16x32_bf16 v[88:91], a[8:11], a[80:83], v[88:91]
    v_mfma_f32_16x16x32_bf16 v[92:95], a[12:15], a[80:83], v[92:95]
    v_mfma_f32_16x16x32_bf16 v[80:83], a[16:19], a[84:87], v[80:83]
    v_mfma_f32_16x16x32_bf16 v[84:87], a[20:23], a[84:87], v[84:87]
    v_mfma_f32_16x16x32_bf16 v[88:91], a[24:27], a[84:87], v[88:91]
    v_mfma_f32_16x16x32_bf16 v[92:95], a[28:31], a[84:87], v[92:95]
    v_mfma_f32_16x16x32_bf16 v[96:99], a[0:3], a[88:91], v[96:99]
    v_mfma_f32_16x16x32_bf16 v[100:103], a[4:7], a[88:91], v[100:103]
    v_mfma_f32_16x16x32_bf16 v[104:107], a[8:11], a[88:91], v[104:107]
    v_mfma_f32_16x16x32_bf16 v[108:111], a[12:15], a[88:91], v[108:111]
    v_mfma_f32_16x16x32_bf16 v[96:99], a[16:19], a[92:95], v[96:99]
    v_mfma_f32_16x16x32_bf16 v[100:103], a[20:23], a[92:95], v[100:103]
    v_mfma_f32_16x16x32_bf16 v[104:107], a[24:27], a[92:95], v[104:107]
    v_mfma_f32_16x16x32_bf16 v[108:111], a[28:31], a[92:95], v[108:111]
    s_nop 7
    v_accvgpr_write_b32 a80, 0
    v_accvgpr_write_b32 a81, 0
    v_accvgpr_write_b32 a82, 0
    v_accvgpr_write_b32 a83, 0
    v_accvgpr_write_b32 a84, 0
    v_accvgpr_write_b32 a85, 0
    v_accvgpr_write_b32 a86, 0
    v_accvgpr_write_b32 a87, 0
    v_accvgpr_write_b32 a88, 0
    v_accvgpr_write_b32 a89, 0
    v_accvgpr_write_b32 a90, 0
    v_accvgpr_write_b32 a91, 0
    v_accvgpr_write_b32 a92, 0
    v_accvgpr_write_b32 a93, 0
    v_accvgpr_write_b32 a94, 0
    v_accvgpr_write_b32 a95, 0
    ds_read_b128 v[28:31], v19 offset:1280
    s_waitcnt lgkmcnt(0)
    v_max3_f32 v28, v28, v29, v30
    v_max3_f32 v28, v28, v31, v20
    v_sub_f32 v29, v20, v28
    v_exp_f32 v29, v29
    v_mov_b32 v20, v28
    v_mul_f32 v48, v48, v29
    v_mul_f32 v49, v49, v29
    v_mul_f32 v50, v50, v29
    v_mul_f32 v51, v51, v29
    v_mul_f32 v52, v52, v29
    v_mul_f32 v53, v53, v29
    v_mul_f32 v54, v54, v29
    v_mul_f32 v55, v55, v29
    v_mul_f32 v56, v56, v29
    v_mul_f32 v57, v57, v29
    v_mul_f32 v58, v58, v29
    v_mul_f32 v59, v59, v29
    v_mul_f32 v60, v60, v29
    v_mul_f32 v61, v61, v29
    v_mul_f32 v62, v62, v29
    v_mul_f32 v63, v63, v29
    ds_read_b128 v[28:31], v19 offset:1536
    s_waitcnt lgkmcnt(0)
    v_max3_f32 v28, v28, v29, v30
    v_max3_f32 v28, v28, v31, v21
    v_sub_f32 v29, v21, v28
    v_exp_f32 v29, v29
    v_mov_b32 v21, v28
    v_mul_f32 v64, v64, v29
    v_mul_f32 v65, v65, v29
    v_mul_f32 v66, v66, v29
    v_mul_f32 v67, v67, v29
    v_mul_f32 v68, v68, v29
    v_mul_f32 v69, v69, v29
    v_mul_f32 v70, v70, v29
    v_mul_f32 v71, v71, v29
    v_mul_f32 v72, v72, v29
    v_mul_f32 v73, v73, v29
    v_mul_f32 v74, v74, v29
    v_mul_f32 v75, v75, v29
    v_mul_f32 v76, v76, v29
    v_mul_f32 v77, v77, v29
    v_mul_f32 v78, v78, v29
    v_mul_f32 v79, v79, v29
    ds_read_b128 v[28:31], v19 offset:1792
    s_waitcnt lgkmcnt(0)
    v_max3_f32 v28, v28, v29, v30
    v_max3_f32 v28, v28, v31, v22
    v_sub_f32 v29, v22, v28
    v_exp_f32 v29, v29
    v_mov_b32 v22, v28
    v_mul_f32 v80, v80, v29
    v_mul_f32 v81, v81, v29
    v_mul_f32 v82, v82, v29
    v_mul_f32 v83, v83, v29
    v_mul_f32 v84, v84, v29
    v_mul_f32 v85, v85, v29
    v_mul_f32 v86, v86, v29
    v_mul_f32 v87, v87, v29
    v_mul_f32 v88, v88, v29
    v_mul_f32 v89, v89, v29
    v_mul_f32 v90, v90, v29
    v_mul_f32 v91, v91, v29
    v_mul_f32 v92, v92, v29
    v_mul_f32 v93, v93, v29
    v_mul_f32 v94, v94, v29
    v_mul_f32 v95, v95, v29
    ds_read_b128 v[28:31], v19 offset:2048
    s_waitcnt lgkmcnt(0)
    v_max3_f32 v28, v28, v29, v30
    v_max3_f32 v28, v28, v31, v23
    v_sub_f32 v29, v23, v28
    v_exp_f32 v29, v29
    v_mov_b32 v23, v28
    v_mul_f32 v96, v96, v29
    v_mul_f32 v97, v97, v29
    v_mul_f32 v98, v98, v29
    v_mul_f32 v99, v99, v29
    v_mul_f32 v100, v100, v29
    v_mul_f32 v101, v101, v29
    v_mul_f32 v102, v102, v29
    v_mul_f32 v103, v103, v29
    v_mul_f32 v104, v104, v29
    v_mul_f32 v105, v105, v29
    v_mul_f32 v106, v106, v29
    v_mul_f32 v107, v107, v29
    v_mul_f32 v108, v108, v29
    v_mul_f32 v109, v109, v29
    v_mul_f32 v110, v110, v29
    v_mul_f32 v111, v111, v29
    s_waitcnt lgkmcnt(0)
    s_barrier
    s_nop 3
    s_branch L_retcb22
L_slowcb23:
    v_and_b32 v25, 0xffff, v17
    v_cmp_ne_u32 vcc, s39, v25
    s_cbranch_vccz L_slowcb23_ready
    s_sleep 1
    ds_read_b32 v17, v14 offset:0
    s_waitcnt lgkmcnt(0)
    v_cmp_ne_u32 vcc, s39, v17
    s_cbranch_vccz L_retcb23
    s_branch L_slowcb23
L_slowcb23_ready:
    s_waitcnt lgkmcnt(0)
    s_nop 11
    v_mfma_f32_16x16x32_bf16 v[80:83], a[32:35], a[80:83], v[80:83]
    v_mfma_f32_16x16x32_bf16 v[84:87], a[36:39], a[80:83], v[84:87]
    v_mfma_f32_16x16x32_bf16 v[88:91], a[40:43], a[80:83], v[88:91]
    v_mfma_f32_16x16x32_bf16 v[92:95], a[44:47], a[80:83], v[92:95]
    v_mfma_f32_16x16x32_bf16 v[80:83], a[48:51], a[84:87], v[80:83]
    v_mfma_f32_16x16x32_bf16 v[84:87], a[52:55], a[84:87], v[84:87]
    v_mfma_f32_16x16x32_bf16 v[88:91], a[56:59], a[84:87], v[88:91]
    v_mfma_f32_16x16x32_bf16 v[92:95], a[60:63], a[84:87], v[92:95]
    v_mfma_f32_16x16x32_bf16 v[96:99], a[32:35], a[88:91], v[96:99]
    v_mfma_f32_16x16x32_bf16 v[100:103], a[36:39], a[88:91], v[100:103]
    v_mfma_f32_16x16x32_bf16 v[104:107], a[40:43], a[88:91], v[104:107]
    v_mfma_f32_16x16x32_bf16 v[108:111], a[44:47], a[88:91], v[108:111]
    v_mfma_f32_16x16x32_bf16 v[96:99], a[48:51], a[92:95], v[96:99]
    v_mfma_f32_16x16x32_bf16 v[100:103], a[52:55], a[92:95], v[100:103]
    v_mfma_f32_16x16x32_bf16 v[104:107], a[56:59], a[92:95], v[104:107]
    v_mfma_f32_16x16x32_bf16 v[108:111], a[60:63], a[92:95], v[108:111]
    s_nop 7
    v_accvgpr_write_b32 a80, 0
    v_accvgpr_write_b32 a81, 0
    v_accvgpr_write_b32 a82, 0
    v_accvgpr_write_b32 a83, 0
    v_accvgpr_write_b32 a84, 0
    v_accvgpr_write_b32 a85, 0
    v_accvgpr_write_b32 a86, 0
    v_accvgpr_write_b32 a87, 0
    v_accvgpr_write_b32 a88, 0
    v_accvgpr_write_b32 a89, 0
    v_accvgpr_write_b32 a90, 0
    v_accvgpr_write_b32 a91, 0
    v_accvgpr_write_b32 a92, 0
    v_accvgpr_write_b32 a93, 0
    v_accvgpr_write_b32 a94, 0
    v_accvgpr_write_b32 a95, 0
    ds_read_b128 v[28:31], v19 offset:0
    s_waitcnt lgkmcnt(0)
    v_max3_f32 v28, v28, v29, v30
    v_max3_f32 v28, v28, v31, v20
    v_sub_f32 v29, v20, v28
    v_exp_f32 v29, v29
    v_mov_b32 v20, v28
    v_mul_f32 v48, v48, v29
    v_mul_f32 v49, v49, v29
    v_mul_f32 v50, v50, v29
    v_mul_f32 v51, v51, v29
    v_mul_f32 v52, v52, v29
    v_mul_f32 v53, v53, v29
    v_mul_f32 v54, v54, v29
    v_mul_f32 v55, v55, v29
    v_mul_f32 v56, v56, v29
    v_mul_f32 v57, v57, v29
    v_mul_f32 v58, v58, v29
    v_mul_f32 v59, v59, v29
    v_mul_f32 v60, v60, v29
    v_mul_f32 v61, v61, v29
    v_mul_f32 v62, v62, v29
    v_mul_f32 v63, v63, v29
    ds_read_b128 v[28:31], v19 offset:256
    s_waitcnt lgkmcnt(0)
    v_max3_f32 v28, v28, v29, v30
    v_max3_f32 v28, v28, v31, v21
    v_sub_f32 v29, v21, v28
    v_exp_f32 v29, v29
    v_mov_b32 v21, v28
    v_mul_f32 v64, v64, v29
    v_mul_f32 v65, v65, v29
    v_mul_f32 v66, v66, v29
    v_mul_f32 v67, v67, v29
    v_mul_f32 v68, v68, v29
    v_mul_f32 v69, v69, v29
    v_mul_f32 v70, v70, v29
    v_mul_f32 v71, v71, v29
    v_mul_f32 v72, v72, v29
    v_mul_f32 v73, v73, v29
    v_mul_f32 v74, v74, v29
    v_mul_f32 v75, v75, v29
    v_mul_f32 v76, v76, v29
    v_mul_f32 v77, v77, v29
    v_mul_f32 v78, v78, v29
    v_mul_f32 v79, v79, v29
    ds_read_b128 v[28:31], v19 offset:512
    s_waitcnt lgkmcnt(0)
    v_max3_f32 v28, v28, v29, v30
    v_max3_f32 v28, v28, v31, v22
    v_sub_f32 v29, v22, v28
    v_exp_f32 v29, v29
    v_mov_b32 v22, v28
    v_mul_f32 v80, v80, v29
    v_mul_f32 v81, v81, v29
    v_mul_f32 v82, v82, v29
    v_mul_f32 v83, v83, v29
    v_mul_f32 v84, v84, v29
    v_mul_f32 v85, v85, v29
    v_mul_f32 v86, v86, v29
    v_mul_f32 v87, v87, v29
    v_mul_f32 v88, v88, v29
    v_mul_f32 v89, v89, v29
    v_mul_f32 v90, v90, v29
    v_mul_f32 v91, v91, v29
    v_mul_f32 v92, v92, v29
    v_mul_f32 v93, v93, v29
    v_mul_f32 v94, v94, v29
    v_mul_f32 v95, v95, v29
    ds_read_b128 v[28:31], v19 offset:768
    s_waitcnt lgkmcnt(0)
    v_max3_f32 v28, v28, v29, v30
    v_max3_f32 v28, v28, v31, v23
    v_sub_f32 v29, v23, v28
    v_exp_f32 v29, v29
    v_mov_b32 v23, v28
    v_mul_f32 v96, v96, v29
    v_mul_f32 v97, v97, v29
    v_mul_f32 v98, v98, v29
    v_mul_f32 v99, v99, v29
    v_mul_f32 v100, v100, v29
    v_mul_f32 v101, v101, v29
    v_mul_f32 v102, v102, v29
    v_mul_f32 v103, v103, v29
    v_mul_f32 v104, v104, v29
    v_mul_f32 v105, v105, v29
    v_mul_f32 v106, v106, v29
    v_mul_f32 v107, v107, v29
    v_mul_f32 v108, v108, v29
    v_mul_f32 v109, v109, v29
    v_mul_f32 v110, v110, v29
    v_mul_f32 v111, v111, v29
    s_waitcnt lgkmcnt(0)
    s_barrier
    s_nop 3
    s_branch L_retcb23
L_done:
    s_endpgm
.section .rodata,"a"
.p2align 6
.amdhsa_kernel standalone__gqa_softmax__near_ridge_kernel
  .amdhsa_next_free_vgpr 256
  .amdhsa_next_free_sgpr 102
  .amdhsa_accum_offset 128
  .amdhsa_group_segment_fixed_size 0
  .amdhsa_kernarg_size 48
  .amdhsa_user_sgpr_count 2
  .amdhsa_user_sgpr_kernarg_segment_ptr 1
  .amdhsa_system_sgpr_workgroup_id_x 1
.end_amdhsa_kernel
```
